```python
import torch

def _softmax(x, axis=-1):
    return torch.softmax(x, dim=axis)

def _gelu(x):
    return torch.nn.functional.gelu(x, approximate='tanh')

def _silu(x):
    return torch.nn.functional.silu(x)

def _sigmoid(x):
    return torch.sigmoid(x)

def _layernorm(x, axis=-1, eps=1e-05):
    m = x.mean(dim=axis, keepdim=True)
    v = x.var(dim=axis, keepdim=True, unbiased=False)
    return (x - m) / torch.sqrt(v + eps)

def _scatter_add(tgt, idx, src, axis=0):
    return tgt.clone().index_add_(axis, idx, src)

def _segment_sum(src, seg, n):
    out = torch.zeros((n,) + src.shape[1:], dtype=src.dtype)
    return out.index_add_(0, seg, src)

def _pad(x, pw):
    flat = tuple((v for pair in reversed(pw) for v in pair))
    return torch.nn.functional.pad(x, flat)
kernel_name = 'adaLN_cond__gqa_block_cached__dense_activation_silu__decode'

def setup_inputs():

    _w = lambda a: (lambda t: t.to(torch.bfloat16) if t.is_floating_point() else t)(torch.as_tensor(a))

    def _A_setup():
        B, Sq, D = (1, 1, 576)
        Hq, Hkv, Sk, Dh = (32, 16, 8192, 128)
        assert Hq % Hkv == 0, (Hq, Hkv)
        return {'x': _w((lambda *s: torch.randn(*s, dtype=torch.bfloat16) * 0.1)(B, Sq, D)), 'k_cache': _w((lambda *s: torch.randn(*s, dtype=torch.bfloat16) * 1.6)(B, Hkv, Sk, Dh)), 'v_cache': _w((lambda *s: torch.randn(*s, dtype=torch.bfloat16) * 3.2)(B, Hkv, Sk, Dh)), 'wq': _w((lambda *s: torch.randn(*s, dtype=torch.bfloat16) * 1.6)(D, Hq * Dh) * D ** (-0.5)), 'wo': _w((lambda *s: torch.randn(*s, dtype=torch.bfloat16) * 3.2)(Hq * Dh, D) * (Hq * Dh) ** (-0.5))}
    _A_in = _A_setup()

    def _B_setup():
        B, S, D, F = (1, 1, 576, 4608)
        return {'x': _w((lambda *s: torch.randn(*s, dtype=torch.bfloat16) * 0.1)(B, S, D)), 'w1': _w((lambda *s: torch.randn(*s, dtype=torch.bfloat16) * 3.2)(D, F) * D ** (-0.5)), 'w2': _w((lambda *s: torch.randn(*s, dtype=torch.bfloat16) * 3.2)(F, D) * F ** (-0.5))}
    _B_in = _B_setup()
    return {'A_x': _A_in['x'], 'A_k_cache': _A_in['k_cache'], 'A_v_cache': _A_in['v_cache'], 'A_wq': _A_in['wq'], 'A_wo': _A_in['wo'], 'B_x': _B_in['x'], 'B_w1': _B_in['w1'], 'B_w2': _B_in['w2'], 'c': _w((lambda *s: torch.randn(*s, dtype=torch.bfloat16) * 0.2)(1, 576) * 8.0), 'w_mod': _w((lambda *s: torch.randn(*s, dtype=torch.bfloat16) * 0.2)(576, 6 * 576) * 576 ** (-0.5) * 8.0)}

def reference(A_x, A_k_cache, A_v_cache, A_wq, A_wo, B_x, B_w1, B_w2, c, w_mod):

    def _A_ref(x, k_cache, v_cache, wq, wo):
        B, Sq, D = x.shape
        Hq, Dh = (32, 128)
        Hkv = k_cache.shape[1]
        rep = Hq // Hkv
        q = (lambda x, *d: x.permute(*d))((x @ wq).reshape(B, Sq, Hq, Dh), 0, 2, 1, 3)
        k = (lambda x, n, axis: torch.repeat_interleave(x, n, dim=axis))(k_cache, rep, axis=1)
        v = (lambda x, n, axis: torch.repeat_interleave(x, n, dim=axis))(v_cache, rep, axis=1)
        scores = torch.einsum('bhqd,bhkd->bhqk', q, k) * Dh ** (-0.5)
        p = _softmax(scores, axis=-1)
        o = torch.einsum('bhqk,bhkd->bhqd', p, v)
        return (lambda x, *d: x.permute(*d))(o, 0, 2, 1, 3).reshape(B, Sq, Hq * Dh) @ wo

    def _B_ref(x, w1, w2):
        h = torch.einsum('bsd,df->bsf', x, w1)
        h = _silu(h)
        out = torch.einsum('bsf,fd->bsd', h, w2)
        return out
    x = A_x
    mod = (_silu(c) @ w_mod).reshape(c.shape[0], 6, 1, -1)
    sa, ca, ga, sb, cb, gb = (mod[:, 0].clone(), mod[:, 1].clone(), mod[:, 2].clone(), mod[:, 3].clone(), mod[:, 4].clone(), mod[:, 5].clone())
    h = _layernorm(x, axis=-1) * (1 + ca) + sa
    x = x + ga * _A_ref(h, A_k_cache, A_v_cache, A_wq, A_wo)
    h = _layernorm(x, axis=-1) * (1 + cb) + sb
    x = x + gb * _B_ref(h, B_w1, B_w2)
    return x
```

```asm
; @launch grid=(256,1,1) block=(704,1,1) lds=93952
.amdgcn_target "amdgcn-amd-amdhsa--gfx950"
.text
.globl adaLN_cond__gqa_block_cached__dense_activation_silu__decode_kernel
.p2align 8
.type adaLN_cond__gqa_block_cached__dense_activation_silu__decode_kernel,@function
adaLN_cond__gqa_block_cached__dense_activation_silu__decode_kernel:
    s_cmp_ge_u32 s2, 256
    s_cbranch_scc1 L_end
    s_load_dwordx16 s[16:31], s[0:1], 0
    s_load_dwordx8 s[32:39], s[0:1], 64
    s_load_dwordx2 s[40:41], s[0:1], 96
    v_lshrrev_b32 v4, 6, v0
    v_and_b32 v1, 63, v0
    v_readfirstlane_b32 s3, v4
    v_lshrrev_b32 v2, 4, v1
    v_and_b32 v3, 15, v1
    s_and_b32 s5, s2, 7
    s_lshl_b32 s5, s5, 1
    s_bfe_u32 s7, s2, 0x10003
    s_or_b32 s5, s5, s7
    s_lshr_b32 s6, s2, 4
    s_lshl_b32 s4, s5, 4
    s_or_b32 s4, s4, s6
    s_mul_i32 s14, s5, 6
    s_add_u32 s14, s14, s6
    s_mul_i32 s82, s5, 9
    s_add_u32 s82, s82, s6
    s_sub_u32 s82, s82, 7
    s_cmp_lt_u32 s6, 6
    s_cselect_b32 s81, 1, 0
    s_cmp_ge_u32 s6, 7
    s_cselect_b32 s81, 2, s81
    s_cmp_eq_u32 s3, 0
    s_cbranch_scc1 L_ctrl
    s_cmp_eq_u32 s3, 9
    s_cbranch_scc1 L_mod
    s_cmp_eq_u32 s3, 10
    s_cbranch_scc1 L_clean
    s_sub_u32 s83, s3, 1
    v_lshlrev_b32 v4, 8, v3
    v_lshl_add_u32 v4, v2, 4, v4
    v_lshlrev_b32 v5, 10, v2
    v_lshl_add_u32 v5, v3, 4, v5
    s_lshl_b32 s7, s4, 17
    s_lshl_b32 s8, s83, 14
    s_add_u32 s7, s7, s8
    s_add_u32 s10, s4, s83
    s_add_u32 s11, s10, 0
    s_and_b32 s11, s11, 3
    s_lshl_b32 s68, s11, 12
    s_add_u32 s11, s10, 1
    s_and_b32 s11, s11, 3
    s_lshl_b32 s69, s11, 12
    s_add_u32 s11, s10, 2
    s_and_b32 s11, s11, 3
    s_lshl_b32 s70, s11, 12
    s_add_u32 s11, s10, 3
    s_and_b32 s11, s11, 3
    s_lshl_b32 s71, s11, 12
    s_cmp_eq_u32 s81, 1
    s_cbranch_scc0 L_dw1_1
    s_lshl_b32 s12, s5, 8
    s_lshl_b32 s13, s83, 5
    s_add_u32 s12, s12, s13
    s_mul_i32 s12, s12, 1152
    s_mul_i32 s13, s6, 192
    s_add_u32 s12, s12, s13
    s_mul_i32 s13, s83, 6144
    s_add_u32 s13, s13, 20224
    s_mov_b32 s79, 0
    s_movk_i32 s10, 0x1556
    s_movk_i32 s11, 0x480
    v_add_u32 v0, 0, v1
    v_mul_u32_u24 v6, s10, v0
    v_lshrrev_b32 v6, 16, v6
    v_mul_u32_u24 v164, 12, v6
    v_sub_u32 v0, v0, v164
    v_mul_u32_u24 v6, s11, v6
    v_lshl_add_u32 v165, v0, 4, v6
    v_add_u32 v0, 64, v1
    v_mul_u32_u24 v6, s10, v0
    v_lshrrev_b32 v6, 16, v6
    v_mul_u32_u24 v164, 12, v6
    v_sub_u32 v0, v0, v164
    v_mul_u32_u24 v6, s11, v6
    v_lshl_add_u32 v166, v0, 4, v6
    v_add_u32 v0, 128, v1
    v_mul_u32_u24 v6, s10, v0
    v_lshrrev_b32 v6, 16, v6
    v_mul_u32_u24 v164, 12, v6
    v_sub_u32 v0, v0, v164
    v_mul_u32_u24 v6, s11, v6
    v_lshl_add_u32 v167, v0, 4, v6
    s_mov_b32 s88, 0
    s_mov_b32 s89, 0
    s_mov_b32 s90, 0
    s_movk_i32 s91, 0x4800
    s_movk_i32 s92, 0x4800
    s_movk_i32 s93, 0x4800
    s_branch L_dwd_2
L_dw1_1:
    s_mul_i32 s12, s3, 589824
    s_lshl_b32 s13, s82, 6
    s_add_u32 s12, s12, s13
    s_mul_i32 s79, s82, 36864
    s_lshl_b32 s13, s3, 7
    s_add_u32 s79, s79, s13
    s_lshl_b32 s13, s3, 13
    s_add_u32 s13, s13, 20224
    v_lshrrev_b32 v165, 2, v1
    s_movk_i32 s10, 0x2400
    v_mul_u32_u24 v165, s10, v165
    v_and_b32 v0, 3, v1
    v_lshl_add_u32 v165, v0, 4, v165
    v_mov_b32 v166, v165
    v_lshrrev_b32 v167, 3, v1
    s_movk_i32 s10, 0x480
    v_mul_u32_u24 v167, s10, v167
    v_and_b32 v0, 7, v1
    v_lshl_add_u32 v167, v0, 4, v167
    s_mov_b32 s88, 0
    s_mov_b32 s89, 147456
    s_mov_b32 s90, 0
    s_mov_b32 s91, 294912
    s_mov_b32 s92, 442368
    s_movk_i32 s93, 0x2400
    s_cmp_eq_u32 s81, 0
    s_cselect_b32 s12, 0, s12
    s_cselect_b32 s79, 0, s79
L_dwd_2:
    s_waitcnt lgkmcnt(0)
    s_add_u32 s48, s18, s7
    s_addc_u32 s49, s19, 0
    s_mov_b32 s50, 16384
    s_mov_b32 s51, 0x20000
    s_add_u32 s52, s20, s7
    s_addc_u32 s53, s21, 0
    s_mov_b32 s54, 16384
    s_mov_b32 s55, 0x20000
    s_cmp_eq_u32 s81, 1
    s_cselect_b32 s56, s24, s28
    s_cselect_b32 s57, s25, s29
    s_mov_b32 s58, 5308416
    s_cselect_b32 s58, 4718592, s58
    s_add_u32 s56, s56, s12
    s_addc_u32 s57, s57, 0
    s_sub_u32 s58, s58, s12
    s_mov_b32 s59, 0x20000
    s_add_u32 s60, s30, s79
    s_addc_u32 s61, s31, 0
    s_sub_u32 s62, 5308416, s79
    s_mov_b32 s63, 0x20000
    s_cmp_eq_u32 s81, 1
    s_cselect_b32 s60, s56, s60
    s_cselect_b32 s61, s57, s61
    s_cselect_b32 s62, s58, s62
    s_cmp_eq_u32 s81, 0
    s_cselect_b32 s58, 0, s58
    s_cselect_b32 s62, 0, s62
    s_barrier
    buffer_load_dwordx4 v[8:11], v4, s[48:51], s68 offen offset:0
    buffer_load_dwordx4 v[12:15], v4, s[48:51], s68 offen offset:64
    buffer_load_dwordx4 v[16:19], v4, s[48:51], s68 offen offset:128
    buffer_load_dwordx4 v[20:23], v4, s[48:51], s68 offen offset:192
    s_waitcnt vmcnt(3)
    buffer_load_dwordx4 v[24:27], v4, s[48:51], s69 offen offset:0
    s_waitcnt vmcnt(3)
    buffer_load_dwordx4 v[28:31], v4, s[48:51], s69 offen offset:64
    s_waitcnt vmcnt(3)
    buffer_load_dwordx4 v[32:35], v4, s[48:51], s69 offen offset:128
    s_waitcnt vmcnt(3)
    buffer_load_dwordx4 v[36:39], v4, s[48:51], s69 offen offset:192
    s_waitcnt vmcnt(3)
    buffer_load_dwordx4 v[40:43], v4, s[48:51], s70 offen offset:0
    s_waitcnt vmcnt(3)
    buffer_load_dwordx4 v[44:47], v4, s[48:51], s70 offen offset:64
    s_waitcnt vmcnt(3)
    buffer_load_dwordx4 v[48:51], v4, s[48:51], s70 offen offset:128
    s_waitcnt vmcnt(3)
    buffer_load_dwordx4 v[52:55], v4, s[48:51], s70 offen offset:192
    s_waitcnt vmcnt(3)
    buffer_load_dwordx4 v[56:59], v4, s[48:51], s71 offen offset:0
    s_waitcnt vmcnt(3)
    buffer_load_dwordx4 v[60:63], v4, s[48:51], s71 offen offset:64
    s_waitcnt vmcnt(3)
    buffer_load_dwordx4 v[64:67], v4, s[48:51], s71 offen offset:128
    s_waitcnt vmcnt(3)
    buffer_load_dwordx4 v[68:71], v4, s[48:51], s71 offen offset:192
    s_waitcnt vmcnt(3)
    buffer_load_dwordx4 v[72:75], v5, s[52:55], s68 offen offset:0
    s_waitcnt vmcnt(3)
    buffer_load_dwordx4 v[76:79], v5, s[52:55], s68 offen offset:256
    s_waitcnt vmcnt(3)
    buffer_load_dwordx4 v[80:83], v5, s[52:55], s68 offen offset:512
    s_waitcnt vmcnt(3)
    buffer_load_dwordx4 v[84:87], v5, s[52:55], s68 offen offset:768
    s_waitcnt vmcnt(3)
    s_mov_b32 s44, s40
    s_mov_b32 s45, s41
    s_mov_b32 s46, 1114112
    s_mov_b32 s47, 0x20000
    s_mul_i32 s85, s4, 2816
    s_movk_i32 s86, 2816
    v_and_b32 v152, 1, v1
    v_cmp_eq_u32 vcc, 1, v152
    v_mov_b32 v152, 0xffff
    v_mov_b32 v153, 0xffff0000
    v_cndmask_b32 v152, v152, v153, vcc
    v_bfe_u32 v153, v1, 1, 2
    v_cmp_eq_u32 vcc, 0, v153
    s_nop 1
    v_cndmask_b32 v160, 0, v152, vcc
    v_cmp_eq_u32 vcc, 1, v153
    s_nop 1
    v_cndmask_b32 v161, 0, v152, vcc
    v_cmp_eq_u32 vcc, 2, v153
    s_nop 1
    v_cndmask_b32 v162, 0, v152, vcc
    v_cmp_eq_u32 vcc, 3, v153
    s_nop 1
    v_cndmask_b32 v163, 0, v152, vcc
    s_mov_b32 s72, 0xffff0000
    s_mov_b32 s73, 0
    s_mov_b32 s74, 0
    s_mov_b32 s75, 0xffff
    s_mov_b32 s76, 0
    s_mov_b32 s77, 0xffff0000
    buffer_load_dwordx4 v[88:91], v5, s[52:55], s69 offen offset:0
    s_waitcnt vmcnt(3)
    buffer_load_dwordx4 v[92:95], v5, s[52:55], s69 offen offset:256
    s_waitcnt vmcnt(3)
    buffer_load_dwordx4 v[96:99], v5, s[52:55], s69 offen offset:512
    s_waitcnt vmcnt(11)
    buffer_load_dwordx4 v[100:103], v5, s[52:55], s69 offen offset:768
    s_waitcnt vmcnt(11)
    buffer_load_dwordx4 v[104:107], v5, s[52:55], s70 offen offset:0
    s_waitcnt vmcnt(11)
    buffer_load_dwordx4 v[108:111], v5, s[52:55], s70 offen offset:256
    s_waitcnt vmcnt(11)
    buffer_load_dwordx4 v[112:115], v5, s[52:55], s70 offen offset:512
    s_waitcnt vmcnt(11)
    buffer_load_dwordx4 v[116:119], v5, s[52:55], s70 offen offset:768
    s_waitcnt vmcnt(11)
    buffer_load_dwordx4 v[120:123], v5, s[52:55], s71 offen offset:0
    s_waitcnt vmcnt(11)
    buffer_load_dwordx4 v[124:127], v5, s[52:55], s71 offen offset:256
    s_waitcnt vmcnt(11)
    buffer_load_dwordx4 v[128:131], v5, s[52:55], s71 offen offset:512
    s_waitcnt vmcnt(11)
    buffer_load_dwordx4 v[132:135], v5, s[52:55], s71 offen offset:768
    s_barrier
    v_lshrrev_b32 v5, 3, v3
    v_lshlrev_b32 v5, 8, v5
    v_lshl_add_u32 v5, v2, 4, v5
    ds_read_b128 v[152:155], v5 offset:0
    ds_read_b128 v[156:159], v5 offset:64
    s_waitcnt vmcnt(16)
    s_waitcnt lgkmcnt(1)
    v_mfma_f32_16x16x32_bf16 v[136:139], v[152:155], v[8:11], 0
    v_mfma_f32_16x16x32_bf16 v[140:143], v[152:155], v[24:27], 0
    v_mfma_f32_16x16x32_bf16 v[144:147], v[152:155], v[40:43], 0
    v_mfma_f32_16x16x32_bf16 v[148:151], v[152:155], v[56:59], 0
    ds_read_b128 v[152:155], v5 offset:128
    s_waitcnt lgkmcnt(1)
    v_mfma_f32_16x16x32_bf16 v[136:139], v[156:159], v[12:15], v[136:139]
    v_mfma_f32_16x16x32_bf16 v[140:143], v[156:159], v[28:31], v[140:143]
    v_mfma_f32_16x16x32_bf16 v[144:147], v[156:159], v[44:47], v[144:147]
    v_mfma_f32_16x16x32_bf16 v[148:151], v[156:159], v[60:63], v[148:151]
    ds_read_b128 v[156:159], v5 offset:192
    s_waitcnt lgkmcnt(1)
    v_mfma_f32_16x16x32_bf16 v[136:139], v[152:155], v[16:19], v[136:139]
    v_mfma_f32_16x16x32_bf16 v[140:143], v[152:155], v[32:35], v[140:143]
    v_mfma_f32_16x16x32_bf16 v[144:147], v[152:155], v[48:51], v[144:147]
    v_mfma_f32_16x16x32_bf16 v[148:151], v[152:155], v[64:67], v[148:151]
    s_waitcnt lgkmcnt(0)
    v_mfma_f32_16x16x32_bf16 v[136:139], v[156:159], v[20:23], v[136:139]
    v_mfma_f32_16x16x32_bf16 v[140:143], v[156:159], v[36:39], v[140:143]
    v_mfma_f32_16x16x32_bf16 v[144:147], v[156:159], v[52:55], v[144:147]
    v_mfma_f32_16x16x32_bf16 v[148:151], v[156:159], v[68:71], v[148:151]
    v_lshrrev_b32 v6, 1, v2
    v_lshlrev_b32 v0, 8, v6
    v_lshlrev_b32 v6, 5, v6
    s_lshl_b32 s7, s83, 2
    v_add_u32 v4, s7, v6
    s_lshl_b32 s9, s83, 9
    s_add_u32 s9, s9, 7424
    v_lshl_add_u32 v0, v3, 2, v0
    v_add_u32 v0, s9, v0
    v_cvt_pk_bf16_f32 v136, 0, v136
    v_cvt_pk_bf16_f32 v140, 0, v140
    v_cvt_pk_bf16_f32 v144, 0, v144
    v_cvt_pk_bf16_f32 v148, 0, v148
    v_mul_f32 v136, 0x3db504f3, v136
    v_mul_f32 v140, 0x3db504f3, v140
    v_mul_f32 v144, 0x3db504f3, v144
    v_mul_f32 v148, 0x3db504f3, v148
    v_cvt_pk_bf16_f32 v136, 0, v136
    v_cvt_pk_bf16_f32 v140, 0, v140
    v_cvt_pk_bf16_f32 v144, 0, v144
    v_cvt_pk_bf16_f32 v148, 0, v148
    v_max3_f32 v137, v136, v140, v144
    v_max_f32 v137, v137, v148
    s_nop 1
    v_max_f32_dpp v137, v137, v137 row_ror:8 row_mask:0xf bank_mask:0xf
    s_nop 1
    v_max_f32_dpp v137, v137, v137 row_ror:4 row_mask:0xf bank_mask:0xf
    s_nop 1
    v_max_f32_dpp v137, v137, v137 row_ror:2 row_mask:0xf bank_mask:0xf
    s_nop 1
    v_max_f32_dpp v137, v137, v137 row_ror:1 row_mask:0xf bank_mask:0xf
    ds_write_b32 v4, v137 offset:2560
    s_waitcnt lgkmcnt(0)
    s_barrier
    ds_read_b128 v[152:155], v6 offset:2560
    ds_read_b128 v[156:159], v6 offset:2576
    v_lshrrev_b32 v5, 3, v3
    v_lshlrev_b32 v5, 8, v5
    v_lshl_add_u32 v5, v2, 4, v5
    v_add_u32 v5, s9, v5
    s_mov_b32 s7, 0x3fb8aa3b
    s_waitcnt lgkmcnt(0)
    v_max3_f32 v137, v152, v153, v154
    v_max3_f32 v138, v155, v156, v157
    v_max3_f32 v137, v137, v158, v159
    v_max_f32 v137, v137, v138
    v_mul_f32 v137, 0xbfb8aa3b, v137
    v_fma_f32 v136, v136, s7, v137
    v_fma_f32 v140, v140, s7, v137
    v_fma_f32 v144, v144, s7, v137
    v_fma_f32 v148, v148, s7, v137
    v_exp_f32 v136, v136
    v_exp_f32 v140, v140
    v_exp_f32 v144, v144
    v_exp_f32 v148, v148
    v_add_f32 v137, v136, v140
    v_add_f32 v138, v144, v148
    v_cvt_pk_bf16_f32 v136, v136, v136
    v_cvt_pk_bf16_f32 v140, v140, v140
    v_cvt_pk_bf16_f32 v144, v144, v144
    v_cvt_pk_bf16_f32 v148, v148, v148
    v_add_f32 v137, v137, v138
    ds_write_b32 v0, v136 offset:0
    ds_write_b32 v0, v140 offset:64
    ds_write_b32 v0, v144 offset:128
    ds_write_b32 v0, v148 offset:192
    v_add_f32_dpp v137, v137, v137 row_ror:8 row_mask:0xf bank_mask:0xf
    s_nop 1
    v_add_f32_dpp v137, v137, v137 row_ror:4 row_mask:0xf bank_mask:0xf
    s_nop 1
    v_add_f32_dpp v137, v137, v137 row_ror:2 row_mask:0xf bank_mask:0xf
    s_nop 1
    v_add_f32_dpp v137, v137, v137 row_ror:1 row_mask:0xf bank_mask:0xf
    ds_read_b128 v[152:155], v5 offset:0
    ds_read_b128 v[140:143], v5 offset:64
    ds_read_b128 v[144:147], v5 offset:128
    ds_read_b128 v[148:151], v5 offset:192
    v_lshrrev_b32 v6, 3, v6
    s_mov_b32 exec_lo, 0x1
    s_mov_b32 exec_hi, 0x1
    ds_add_f32 v6, v137 offset:2624
    s_mov_b64 exec, -1
    s_waitcnt lgkmcnt(0)
    s_barrier
    v_mov_b32 v136, v152
    v_mov_b32 v137, v153
    v_mov_b32 v138, v154
    v_mov_b32 v139, v155
    v_lshrrev_b32 v4, 1, v2
    v_lshlrev_b32 v4, 9, v4
    v_lshl_add_u32 v4, v3, 5, v4
    v_and_b32 v5, 1, v2
    v_lshl_add_u32 v4, v5, 4, v4
    s_lshl_b32 s7, s83, 10
    v_add_u32 v4, s7, v4
    v_and_b32 v152, v136, v160
    v_and_b32 v153, v136, v161
    v_and_b32 v154, v136, v162
    v_and_b32 v155, v136, v163
    s_waitcnt vmcnt(15)
    s_nop 0
    v_mfma_f32_16x16x32_bf16 v[48:51], v[152:155], v[72:75], 0
    v_and_b32 v156, v137, v160
    v_and_b32 v157, v137, v161
    v_and_b32 v158, v137, v162
    v_and_b32 v159, v137, v163
    s_waitcnt vmcnt(14)
    s_nop 0
    v_mfma_f32_16x16x32_bf16 v[48:51], v[156:159], v[76:79], v[48:51]
    v_and_b32 v152, v138, v160
    v_and_b32 v153, v138, v161
    v_and_b32 v154, v138, v162
    v_and_b32 v155, v138, v163
    s_waitcnt vmcnt(13)
    s_nop 0
    v_mfma_f32_16x16x32_bf16 v[48:51], v[152:155], v[80:83], v[48:51]
    v_and_b32 v156, v139, v160
    v_and_b32 v157, v139, v161
    v_and_b32 v158, v139, v162
    v_and_b32 v159, v139, v163
    s_waitcnt vmcnt(12)
    s_nop 0
    v_mfma_f32_16x16x32_bf16 v[48:51], v[156:159], v[84:87], v[48:51]
    v_and_b32 v152, v140, v160
    v_and_b32 v153, v140, v161
    v_and_b32 v154, v140, v162
    v_and_b32 v155, v140, v163
    s_waitcnt vmcnt(11)
    s_nop 0
    v_mfma_f32_16x16x32_bf16 v[48:51], v[152:155], v[88:91], v[48:51]
    v_and_b32 v156, v141, v160
    v_and_b32 v157, v141, v161
    v_and_b32 v158, v141, v162
    v_and_b32 v159, v141, v163
    s_waitcnt vmcnt(10)
    s_nop 0
    v_mfma_f32_16x16x32_bf16 v[48:51], v[156:159], v[92:95], v[48:51]
    v_and_b32 v152, v142, v160
    v_and_b32 v153, v142, v161
    v_and_b32 v154, v142, v162
    v_and_b32 v155, v142, v163
    s_waitcnt vmcnt(9)
    s_nop 0
    v_mfma_f32_16x16x32_bf16 v[48:51], v[152:155], v[96:99], v[48:51]
    v_and_b32 v156, v143, v160
    v_and_b32 v157, v143, v161
    v_and_b32 v158, v143, v162
    v_and_b32 v159, v143, v163
    s_waitcnt vmcnt(8)
    s_nop 0
    v_mfma_f32_16x16x32_bf16 v[48:51], v[156:159], v[100:103], v[48:51]
    v_and_b32 v152, v144, v160
    v_and_b32 v153, v144, v161
    v_and_b32 v154, v144, v162
    v_and_b32 v155, v144, v163
    s_waitcnt vmcnt(7)
    s_nop 0
    v_mfma_f32_16x16x32_bf16 v[48:51], v[152:155], v[104:107], v[48:51]
    v_and_b32 v156, v145, v160
    v_and_b32 v157, v145, v161
    v_and_b32 v158, v145, v162
    v_and_b32 v159, v145, v163
    s_waitcnt vmcnt(6)
    s_nop 0
    v_mfma_f32_16x16x32_bf16 v[48:51], v[156:159], v[108:111], v[48:51]
    v_and_b32 v152, v146, v160
    v_and_b32 v153, v146, v161
    v_and_b32 v154, v146, v162
    v_and_b32 v155, v146, v163
    s_waitcnt vmcnt(5)
    s_nop 0
    v_mfma_f32_16x16x32_bf16 v[48:51], v[152:155], v[112:115], v[48:51]
    s_add_u32 m0, s13, 0
    s_nop 0
    buffer_load_dwordx4 v165, s[56:59], s88 offen lds
    v_and_b32 v156, v147, v160
    v_and_b32 v157, v147, v161
    v_and_b32 v158, v147, v162
    v_and_b32 v159, v147, v163
    s_waitcnt vmcnt(5)
    s_nop 0
    v_mfma_f32_16x16x32_bf16 v[48:51], v[156:159], v[116:119], v[48:51]
    s_add_u32 m0, s13, 1024
    s_nop 0
    buffer_load_dwordx4 v166, s[56:59], s89 offen lds
    v_and_b32 v152, v148, v160
    v_and_b32 v153, v148, v161
    v_and_b32 v154, v148, v162
    v_and_b32 v155, v148, v163
    s_waitcnt vmcnt(5)
    s_nop 0
    v_mfma_f32_16x16x32_bf16 v[48:51], v[152:155], v[120:123], v[48:51]
    s_add_u32 m0, s13, 2048
    s_nop 0
    buffer_load_dwordx4 v167, s[60:63], s90 offen lds
    v_and_b32 v156, v149, v160
    v_and_b32 v157, v149, v161
    v_and_b32 v158, v149, v162
    v_and_b32 v159, v149, v163
    s_waitcnt vmcnt(5)
    s_nop 0
    v_mfma_f32_16x16x32_bf16 v[48:51], v[156:159], v[124:127], v[48:51]
    s_add_u32 m0, s13, 3072
    s_nop 0
    buffer_load_dwordx4 v165, s[56:59], s91 offen lds
    v_and_b32 v152, v150, v160
    v_and_b32 v153, v150, v161
    v_and_b32 v154, v150, v162
    v_and_b32 v155, v150, v163
    s_waitcnt vmcnt(5)
    s_nop 0
    v_mfma_f32_16x16x32_bf16 v[48:51], v[152:155], v[128:131], v[48:51]
    s_add_u32 m0, s13, 4096
    s_nop 0
    buffer_load_dwordx4 v166, s[56:59], s92 offen lds
    v_and_b32 v156, v151, v160
    v_and_b32 v157, v151, v161
    v_and_b32 v158, v151, v162
    v_and_b32 v159, v151, v163
    s_waitcnt vmcnt(5)
    s_nop 0
    v_mfma_f32_16x16x32_bf16 v[48:51], v[156:159], v[132:135], v[48:51]
    s_add_u32 m0, s13, 5120
    s_nop 0
    buffer_load_dwordx4 v167, s[60:63], s93 offen lds
    s_nop 4
    ds_write_b128 v4, v[48:51] offset:12032
    s_waitcnt lgkmcnt(0)
    s_barrier
    s_cmp_eq_u32 s81, 2
    s_cbranch_scc1 L_mlp_tail
    s_cmp_eq_u32 s81, 1
    s_cbranch_scc1 L_wo_tail
    s_endpgm
L_wo_tail:
    v_lshrrev_b32 v6, 2, v3
    v_lshl_add_u32 v4, v2, 3, v6
    s_movk_i32 s7, 192
    v_mul_u32_u24 v4, s7, v4
    v_and_b32 v6, 3, v3
    v_lshl_add_u32 v4, v6, 3, v4
    v_add_u32 v86, s13, v4
    v_bfe_u32 v6, v1, 1, 3
    s_lshl_b32 s7, s5, 4
    v_add_u32 v4, s7, v6
    v_mul_u32_u24 v4, s86, v4
    v_and_b32 v5, 1, v1
    v_lshlrev_b32 v5, 4, v5
    v_lshl_add_u32 v5, v2, 5, v5
    s_lshl_b32 s7, s83, 7
    v_add3_u32 v84, v4, v5, s7
    s_lshr_b32 s7, s83, 2
    s_lshl_b32 s7, s7, 6
    v_lshl_add_u32 v85, v6, 2, s7
    s_mov_b32 s84, 22528
    s_waitcnt vmcnt(0)
    ds_read_b64_tr_b16 v[8:9], v86 offset:0
    ds_read_b64_tr_b16 v[10:11], v86 offset:768
    ds_read_b64_tr_b16 v[12:13], v86 offset:32
    ds_read_b64_tr_b16 v[14:15], v86 offset:800
    ds_read_b64_tr_b16 v[16:17], v86 offset:64
    ds_read_b64_tr_b16 v[18:19], v86 offset:832
    ds_read_b64_tr_b16 v[20:21], v86 offset:96
    ds_read_b64_tr_b16 v[22:23], v86 offset:864
    ds_read_b64_tr_b16 v[24:25], v86 offset:128
    ds_read_b64_tr_b16 v[26:27], v86 offset:896
    ds_read_b64_tr_b16 v[28:29], v86 offset:160
    ds_read_b64_tr_b16 v[30:31], v86 offset:928
    s_barrier
    ds_read_b32 v80, v85 offset:2688
    ds_read_b32 v81, v85 offset:2720
    s_mov_b32 s80, 0
L_pollo_3:
    buffer_load_dwordx4 v[72:75], v84, s[44:47], 0 offen offset:1536 sc1
    buffer_load_dwordx4 v[76:79], v84, s[44:47], s84 offen offset:1536 sc1
    s_waitcnt vmcnt(0)
    v_max3_u32 v87, v72, v73, v74
    v_max3_u32 v87, v87, v75, v76
    v_max3_u32 v87, v87, v77, v78
    v_max_u32 v87, v87, v79
    v_cmp_eq_u32 vcc, -1, v87
    s_nop 0
    s_cbranch_vccz L_pdo_4
    s_add_u32 s80, s80, 1
    s_cmp_lt_u32 s80, 200000
    s_cbranch_scc1 L_pollo_3
L_pdo_4:
    s_waitcnt lgkmcnt(0)
    v_mul_f32 v72, v80, v72
    v_mul_f32 v73, v80, v73
    v_mul_f32 v74, v80, v74
    v_mul_f32 v75, v80, v75
    v_fmac_f32 v72, v81, v76
    v_fmac_f32 v73, v81, v77
    v_fmac_f32 v74, v81, v78
    v_fmac_f32 v75, v81, v79
    v_add_f32_dpp v72, v72, v72 quad_perm:[2,3,0,1] row_mask:0xf bank_mask:0xf
    v_add_f32_dpp v73, v73, v73 quad_perm:[2,3,0,1] row_mask:0xf bank_mask:0xf
    v_add_f32_dpp v74, v74, v74 quad_perm:[2,3,0,1] row_mask:0xf bank_mask:0xf
    v_add_f32_dpp v75, v75, v75 quad_perm:[2,3,0,1] row_mask:0xf bank_mask:0xf
    v_add_f32_dpp v72, v72, v72 row_ror:4 row_mask:0xf bank_mask:0xf
    v_add_f32_dpp v73, v73, v73 row_ror:4 row_mask:0xf bank_mask:0xf
    v_add_f32_dpp v74, v74, v74 row_ror:4 row_mask:0xf bank_mask:0xf
    v_add_f32_dpp v75, v75, v75 row_ror:4 row_mask:0xf bank_mask:0xf
    v_add_f32_dpp v72, v72, v72 row_ror:8 row_mask:0xf bank_mask:0xf
    v_add_f32_dpp v73, v73, v73 row_ror:8 row_mask:0xf bank_mask:0xf
    v_add_f32_dpp v74, v74, v74 row_ror:8 row_mask:0xf bank_mask:0xf
    v_add_f32_dpp v75, v75, v75 row_ror:8 row_mask:0xf bank_mask:0xf
    v_cvt_pk_bf16_f32 v88, v72, v73
    v_cvt_pk_bf16_f32 v89, v74, v75
    s_nop 0
    v_mov_b32_dpp v96, v88 quad_perm:[0,0,2,2] row_mask:0xf bank_mask:0xf
    v_mov_b32_dpp v97, v89 quad_perm:[0,0,2,2] row_mask:0xf bank_mask:0xf
    v_mov_b32_dpp v98, v88 quad_perm:[1,1,3,3] row_mask:0xf bank_mask:0xf
    v_mov_b32_dpp v99, v89 quad_perm:[1,1,3,3] row_mask:0xf bank_mask:0xf
    s_nop 1
    v_mfma_f32_16x16x32_bf16 v[100:103], v[96:99], v[8:11], 0
    v_mfma_f32_16x16x32_bf16 v[104:107], v[96:99], v[12:15], 0
    v_mfma_f32_16x16x32_bf16 v[108:111], v[96:99], v[16:19], 0
    v_mfma_f32_16x16x32_bf16 v[112:115], v[96:99], v[20:23], 0
    v_mfma_f32_16x16x32_bf16 v[116:119], v[96:99], v[24:27], 0
    v_mfma_f32_16x16x32_bf16 v[120:123], v[96:99], v[28:31], 0
    v_lshlrev_b32 v4, 2, v1
    s_lshl_b32 s7, s83, 9
    v_add_u32 v5, s7, v4
    s_nop 0
    v_cndmask_b32 v88, v100, v104, s[72:73]
    v_cndmask_b32 v88, v88, v108, s[74:75]
    v_cndmask_b32 v88, v88, v112, s[76:77]
    s_nop 0
    v_cndmask_b32 v89, v116, v120, s[72:73]
    ds_write_b32 v5, v88 offset:2816
    ds_write_b32 v5, v89 offset:3072
    s_waitcnt lgkmcnt(0)
    s_barrier
    s_cmp_lt_u32 s83, 2
    s_cbranch_scc0 L_wo_done_5
    s_lshl_b32 s7, s83, 8
    v_add_u32 v4, s7, v4
    ds_read2st64_b32 v[88:89], v4 offset0:11 offset1:13
    ds_read2st64_b32 v[90:91], v4 offset0:15 offset1:17
    ds_read2st64_b32 v[92:93], v4 offset0:19 offset1:21
    ds_read2st64_b32 v[94:95], v4 offset0:23 offset1:25
    s_mul_i32 s7, s14, 384
    s_add_u32 s7, s7, 0xb0000
    s_cmp_eq_u32 s83, 0
    s_cselect_b32 exec_hi, -1, 0
    s_waitcnt lgkmcnt(0)
    v_add_f32 v88, v88, v89
    v_add_f32 v90, v90, v91
    v_add_f32 v92, v92, v93
    v_add_f32 v94, v94, v95
    v_add_f32 v88, v88, v90
    v_add_f32 v92, v92, v94
    v_add_f32 v88, v88, v92
    buffer_store_dword v88, v4, s[44:47], s7 offen sc1
L_wo_done_5:
    s_endpgm
L_mlp_tail:
    s_lshl_b32 s13, s3, 13
    s_add_u32 s13, s13, 20224
    v_lshrrev_b32 v4, 2, v1
    s_movk_i32 s7, 0x2400
    v_mul_u32_u24 v4, s7, v4
    v_and_b32 v5, 3, v1
    v_lshl_add_u32 v96, v5, 4, v4
    s_mul_i32 s7, s3, 589824
    s_lshl_b32 s8, s82, 6
    s_add_u32 s7, s7, s8
    s_add_u32 s56, s28, s7
    s_addc_u32 s57, s29, 0
    s_sub_u32 s58, 5308416, s7
    s_mov_b32 s59, 0x20000
    v_lshrrev_b32 v4, 3, v1
    s_movk_i32 s7, 0x480
    v_mul_u32_u24 v4, s7, v4
    v_and_b32 v5, 7, v1
    v_lshl_add_u32 v97, v5, 4, v4
    s_mul_i32 s7, s82, 36864
    s_lshl_b32 s8, s3, 7
    s_add_u32 s7, s7, s8
    s_add_u32 s60, s30, s7
    s_addc_u32 s61, s31, 0
    s_sub_u32 s62, 5308416, s7
    s_mov_b32 s63, 0x20000
    s_cmp_lg_u32 s3, 0
    s_cbranch_scc1 L_w1done_6
    s_add_u32 m0, s13, 0
    s_mov_b32 s84, 0
    buffer_load_dwordx4 v96, s[56:59], s84 offen lds
    s_add_u32 m0, s13, 1024
    s_mov_b32 s84, 147456
    buffer_load_dwordx4 v96, s[56:59], s84 offen lds
    s_add_u32 m0, s13, 3072
    s_mov_b32 s84, 294912
    buffer_load_dwordx4 v96, s[56:59], s84 offen lds
    s_add_u32 m0, s13, 4096
    s_mov_b32 s84, 442368
    buffer_load_dwordx4 v96, s[56:59], s84 offen lds
    s_add_u32 m0, s13, 2048
    s_mov_b32 s84, 0
    buffer_load_dwordx4 v97, s[60:63], s84 offen lds
    s_add_u32 m0, s13, 5120
    s_mov_b32 s84, 9216
    buffer_load_dwordx4 v97, s[60:63], s84 offen lds
L_w1done_6:
    s_add_u32 m0, s13, 6144
    s_mov_b32 s84, 18432
    buffer_load_dwordx4 v97, s[60:63], s84 offen lds
    s_add_u32 m0, s13, 7168
    s_mov_b32 s84, 27648
    buffer_load_dwordx4 v97, s[60:63], s84 offen lds
    v_lshlrev_b32 v77, 2, v1
    s_lshl_b32 s7, s3, 7
    v_lshl_add_u32 v4, v1, 1, s7
    s_mov_b32 s64, s16
    s_mov_b32 s65, s17
    s_mov_b32 s66, 1152
    s_mov_b32 s67, 0x20000
    buffer_load_ushort v72, v4, s[64:67], 0 offen
    s_lshl_b32 s7, s3, 6
    s_add_u32 s7, s7, 0
    s_lshr_b32 s8, s7, 7
    s_lshl_b32 s8, s8, 9
    s_and_b32 s7, s7, 127
    s_lshl_b32 s7, s7, 2
    s_add_u32 s8, s8, s7
    s_add_u32 s88, s8, 0x10b000
    s_lshl_b32 s7, s3, 6
    s_add_u32 s7, s7, 576
    s_lshr_b32 s8, s7, 7
    s_lshl_b32 s8, s8, 9
    s_and_b32 s7, s7, 127
    s_lshl_b32 s7, s7, 2
    s_add_u32 s8, s8, s7
    s_add_u32 s89, s8, 0x10b000
    s_lshl_b32 s7, s3, 6
    s_add_u32 s7, s7, 1152
    s_lshr_b32 s8, s7, 7
    s_lshl_b32 s8, s8, 9
    s_and_b32 s7, s7, 127
    s_lshl_b32 s7, s7, 2
    s_add_u32 s8, s8, s7
    s_add_u32 s90, s8, 0x10b000
    s_lshl_b32 s7, s3, 6
    s_add_u32 s7, s7, 1728
    s_lshr_b32 s8, s7, 7
    s_lshl_b32 s8, s8, 9
    s_and_b32 s7, s7, 127
    s_lshl_b32 s7, s7, 2
    s_add_u32 s8, s8, s7
    s_add_u32 s91, s8, 0x10b000
    s_lshl_b32 s7, s3, 8
    s_add_u32 s15, s7, 0xb0000
    v_lshrrev_b32 v4, 2, v3
    v_lshl_add_u32 v4, v2, 3, v4
    v_and_b32 v5, 3, v3
    v_lshlrev_b32 v5, 3, v5
    v_lshl_add_u32 v98, v4, 6, v5
    v_add_u32 v98, s13, v98
    v_lshrrev_b32 v4, 2, v3
    v_lshl_add_u32 v99, v4, 7, v5
    v_lshl_add_u32 v99, v2, 10, v99
    v_cmp_eq_u32 vcc, 0, v2
    v_mov_b32 v4, 4096
    v_mov_b32 v5, 2048
    v_cndmask_b32 v4, v4, v5, vcc
    v_add3_u32 v99, v99, v4, s13
    s_mov_b32 s80, 0
L_polls_7:
    buffer_load_dword v73, v77, s[44:47], s88 offen sc1
    buffer_load_dword v74, v77, s[44:47], s89 offen sc1
    buffer_load_dword v75, v77, s[44:47], s90 offen sc1
    buffer_load_dword v76, v77, s[44:47], s91 offen sc1
    s_waitcnt vmcnt(0)
    v_max3_u32 v100, v73, v74, v75
    v_max_u32 v100, v100, v76
    v_cmp_eq_u32 vcc, -1, v100
    s_nop 0
    s_cbranch_vccz L_pds_8
    s_add_u32 s80, s80, 1
    s_cmp_lt_u32 s80, 200000
    s_cbranch_scc1 L_polls_7
L_pds_8:
    ds_read_b64_tr_b16 v[8:9], v98 offset:0
    ds_read_b64_tr_b16 v[10:11], v98 offset:256
    ds_read_b64_tr_b16 v[12:13], v98 offset:32
    ds_read_b64_tr_b16 v[14:15], v98 offset:288
    ds_read_b64_tr_b16 v[16:17], v98 offset:3072
    ds_read_b64_tr_b16 v[18:19], v98 offset:3328
    ds_read_b64_tr_b16 v[20:21], v98 offset:3104
    ds_read_b64_tr_b16 v[22:23], v98 offset:3360
    ds_read_b64_tr_b16 v[24:25], v99 offset:0
    ds_read_b64_tr_b16 v[26:27], v99 offset:512
    ds_read_b64_tr_b16 v[28:29], v99 offset:32
    ds_read_b64_tr_b16 v[30:31], v99 offset:544
    ds_read_b64_tr_b16 v[32:33], v99 offset:64
    ds_read_b64_tr_b16 v[34:35], v99 offset:576
    ds_read_b64_tr_b16 v[36:37], v99 offset:96
    ds_read_b64_tr_b16 v[38:39], v99 offset:608
    v_lshlrev_b32 v72, 16, v72
    v_add_f32 v75, 1.0, v75
    v_cvt_pk_bf16_f32 v75, 0, v75
    s_cmp_eq_u32 s3, 0
    s_cbranch_scc0 L_nocan_9
    v_lshlrev_b32 v4, 7, v1
    s_mov_b32 s12, 0x10d400
    s_mov_b32 exec_lo, 0xffff
    s_mov_b32 exec_hi, 0x0
    s_mov_b32 s80, 0
L_pollc4_10:
    buffer_load_dword v100, v4, s[44:47], s12 offen sc1
    s_sleep 1
    s_waitcnt vmcnt(0)
    v_xor_b32 v101, s95, v100
    v_cmp_ne_u32 vcc, 0, v101
    s_nop 0
    s_cbranch_vccz L_pdc4_11
    s_add_u32 s80, s80, 1
    s_cmp_lt_u32 s80, 200000
    s_cbranch_scc1 L_pollc4_10
L_pdc4_11:
    s_mov_b64 exec, -1
L_nocan_9:
    s_waitcnt lgkmcnt(0)
    s_barrier
    s_mov_b32 s80, 0
L_pollx_12:
    s_mov_b32 s84, s15
    buffer_load_dword v80, v77, s[44:47], s84 offen sc1
    s_add_u32 s84, s84, 2304
    buffer_load_dword v81, v77, s[44:47], s84 offen sc1
    s_add_u32 s84, s84, 2304
    buffer_load_dword v82, v77, s[44:47], s84 offen sc1
    s_add_u32 s84, s84, 2304
    buffer_load_dword v83, v77, s[44:47], s84 offen sc1
    s_add_u32 s84, s84, 2304
    buffer_load_dword v84, v77, s[44:47], s84 offen sc1
    s_add_u32 s84, s84, 2304
    buffer_load_dword v85, v77, s[44:47], s84 offen sc1
    s_add_u32 s84, s84, 2304
    buffer_load_dword v86, v77, s[44:47], s84 offen sc1
    s_add_u32 s84, s84, 2304
    buffer_load_dword v87, v77, s[44:47], s84 offen sc1
    s_add_u32 s84, s84, 2304
    buffer_load_dword v88, v77, s[44:47], s84 offen sc1
    s_add_u32 s84, s84, 2304
    buffer_load_dword v89, v77, s[44:47], s84 offen sc1
    s_add_u32 s84, s84, 2304
    buffer_load_dword v90, v77, s[44:47], s84 offen sc1
    s_add_u32 s84, s84, 2304
    buffer_load_dword v91, v77, s[44:47], s84 offen sc1
    s_add_u32 s84, s84, 2304
    buffer_load_dword v92, v77, s[44:47], s84 offen sc1
    s_add_u32 s84, s84, 2304
    buffer_load_dword v93, v77, s[44:47], s84 offen sc1
    s_add_u32 s84, s84, 2304
    buffer_load_dword v94, v77, s[44:47], s84 offen sc1
    s_add_u32 s84, s84, 2304
    buffer_load_dword v95, v77, s[44:47], s84 offen sc1
    s_waitcnt vmcnt(0)
    v_max3_u32 v100, v80, v81, v82
    v_max3_u32 v100, v100, v83, v84
    v_max3_u32 v100, v100, v85, v86
    v_max3_u32 v100, v100, v87, v88
    v_max3_u32 v100, v100, v89, v90
    v_max3_u32 v100, v100, v91, v92
    v_max3_u32 v100, v100, v93, v94
    v_max_u32 v100, v100, v95
    v_cmp_eq_u32 vcc, -1, v100
    s_nop 0
    s_cbranch_vccz L_pdx_13
    s_add_u32 s80, s80, 1
    s_cmp_lt_u32 s80, 200000
    s_cbranch_scc1 L_pollx_12
L_pdx_13:
    v_add_f32 v80, v80, v81
    v_add_f32 v82, v82, v83
    v_add_f32 v84, v84, v85
    v_add_f32 v86, v86, v87
    v_add_f32 v88, v88, v89
    v_add_f32 v90, v90, v91
    v_add_f32 v92, v92, v93
    v_add_f32 v94, v94, v95
    v_add_f32 v80, v80, v82
    v_add_f32 v84, v84, v86
    v_add_f32 v88, v88, v90
    v_add_f32 v92, v92, v94
    v_add_f32 v80, v80, v84
    v_add_f32 v88, v88, v92
    v_add_f32 v80, v80, v88
    v_cvt_pk_bf16_f32 v80, 0, v80
    v_mul_f32 v80, v80, v73
    v_cvt_pk_bf16_f32 v80, 0, v80
    v_add_f32 v80, v80, v72
    v_cvt_pk_bf16_f32 v81, 0, v80
    v_mov_b32 v100, v81
    v_mul_f32 v101, v81, v81
    s_nop 0
    v_add_f32_dpp v100, v100, v100 row_ror:8 row_mask:0xf bank_mask:0xf
    v_add_f32_dpp v101, v101, v101 row_ror:8 row_mask:0xf bank_mask:0xf
    s_nop 0
    v_add_f32_dpp v100, v100, v100 row_ror:4 row_mask:0xf bank_mask:0xf
    v_add_f32_dpp v101, v101, v101 row_ror:4 row_mask:0xf bank_mask:0xf
    s_nop 0
    v_add_f32_dpp v100, v100, v100 row_ror:2 row_mask:0xf bank_mask:0xf
    v_add_f32_dpp v101, v101, v101 row_ror:2 row_mask:0xf bank_mask:0xf
    s_nop 0
    v_add_f32_dpp v100, v100, v100 row_ror:1 row_mask:0xf bank_mask:0xf
    v_add_f32_dpp v101, v101, v101 row_ror:1 row_mask:0xf bank_mask:0xf
    s_nop 0
    v_add_f32_dpp v100, v100, v100 row_bcast:15 row_mask:0xa bank_mask:0xf
    v_add_f32_dpp v101, v101, v101 row_bcast:15 row_mask:0xa bank_mask:0xf
    s_nop 0
    v_add_f32_dpp v100, v100, v100 row_bcast:31 row_mask:0xc bank_mask:0xf
    v_add_f32_dpp v101, v101, v101 row_bcast:31 row_mask:0xc bank_mask:0xf
    v_mov_b32 v4, 0
    s_mov_b32 exec_lo, 0x0
    s_mov_b32 exec_hi, 0x80000000
    ds_add_f32 v4, v100 offset:2632
    ds_add_f32 v4, v101 offset:2636
    s_mov_b64 exec, -1
    s_lshl_b32 s9, s3, 9
    s_add_u32 s9, s9, 7424
    v_lshl_add_u32 v5, v1, 1, s9
    v_lshl_add_u32 v6, v2, 4, s9
    s_waitcnt lgkmcnt(0)
    s_barrier
    ds_read_b64 v[100:101], v4 offset:2632
    s_waitcnt lgkmcnt(0)
    v_mul_f32 v100, 0x3ae38e39, v100
    v_mul_f32 v101, 0x3ae38e39, v101
    v_fma_f32 v101, -v100, v100, v101
    v_cvt_pk_bf16_f32 v102, 0, v100
    v_max_f32 v101, 0, v101
    v_cvt_pk_bf16_f32 v101, 0, v101
    v_add_f32 v101, 0x3727c5ac, v101
    v_cvt_pk_bf16_f32 v101, 0, v101
    v_sqrt_f32 v101, v101
    s_nop 0
    v_cvt_pk_bf16_f32 v101, 0, v101
    v_rcp_f32 v103, v101
    v_sub_f32 v82, v81, v102
    v_cvt_pk_bf16_f32 v82, 0, v82
    v_mul_f32 v82, v82, v103
    v_cvt_pk_bf16_f32 v82, 0, v82
    v_mul_f32 v82, v82, v75
    v_cvt_pk_bf16_f32 v82, 0, v82
    v_add_f32 v82, v82, v74
    v_cvt_pk_bf16_f32 v82, v82, v82
    ds_write_b16 v5, v82
    ds_read_b128 v[104:107], v6
    ds_read_b128 v[108:111], v6 offset:64
    s_waitcnt lgkmcnt(1)
    v_mfma_f32_16x16x32_bf16 v[112:115], v[104:107], v[8:11], 0
    v_mfma_f32_16x16x32_bf16 v[116:119], v[104:107], v[12:15], 0
    s_waitcnt lgkmcnt(0)
    v_mfma_f32_16x16x32_bf16 v[112:115], v[108:111], v[16:19], v[112:115]
    v_mfma_f32_16x16x32_bf16 v[116:119], v[108:111], v[20:23], v[116:119]
    s_nop 7
    v_cndmask_b32 v100, v112, v116, s[72:73]
    s_lshl_b32 s7, s3, 8
    v_add_u32 v4, s7, v77
    ds_write_b32 v4, v100 offset:2816
    s_waitcnt lgkmcnt(0)
    s_barrier
    ds_read2st64_b32 v[100:101], v77 offset0:11 offset1:12
    ds_read2st64_b32 v[102:103], v77 offset0:13 offset1:14
    ds_read2st64_b32 v[104:105], v77 offset0:15 offset1:16
    ds_read2st64_b32 v[106:107], v77 offset0:17 offset1:18
    ds_read_b32 v108, v77 offset:4864
    s_waitcnt lgkmcnt(0)
    v_add_f32 v100, v100, v101
    v_add_f32 v102, v102, v103
    v_add_f32 v104, v104, v105
    v_add_f32 v106, v106, v107
    v_add_f32 v100, v100, v102
    v_add_f32 v104, v104, v106
    v_add_f32 v100, v100, v108
    v_add_f32 v100, v100, v104
    v_cvt_pk_bf16_f32 v100, 0, v100
    v_mul_f32 v101, 0xbfb8aa3b, v100
    v_exp_f32 v101, v101
    s_nop 0
    v_add_f32 v101, 1.0, v101
    v_rcp_f32 v101, v101
    s_nop 0
    v_mul_f32 v100, v100, v101
    v_cvt_pk_bf16_f32 v100, v100, v100
    ds_write_b16 v5, v100 offset:256
    ds_read_b128 v[104:107], v6 offset:256
    s_waitcnt lgkmcnt(0)
    v_mfma_f32_16x16x32_bf16 v[112:115], v[104:107], v[24:27], 0
    v_mfma_f32_16x16x32_bf16 v[116:119], v[104:107], v[28:31], 0
    v_mfma_f32_16x16x32_bf16 v[120:123], v[104:107], v[32:35], 0
    v_mfma_f32_16x16x32_bf16 v[124:127], v[104:107], v[36:39], 0
    s_lshl_b32 s7, s3, 8
    s_mul_i32 s8, s82, 2304
    s_add_u32 s7, s7, s8
    s_add_u32 s7, s7, 0xba000
    s_nop 1
    v_cndmask_b32 v100, v112, v116, s[72:73]
    v_cndmask_b32 v100, v100, v120, s[74:75]
    v_cndmask_b32 v100, v100, v124, s[76:77]
    buffer_store_dword v100, v77, s[44:47], s7 offen sc1
    s_cmp_lt_u32 s82, 9
    s_cbranch_scc0 L_mlp_done_14
    s_mul_i32 s7, s3, 36864
    s_lshl_b32 s8, s82, 8
    s_add_u32 s12, s7, s8
    s_add_u32 s12, s12, 0xba000
    s_mov_b32 s80, 0
L_pollf_15:
    s_mov_b32 s84, s12
    buffer_load_dword v84, v77, s[44:47], s84 offen sc1
    s_add_u32 s84, s84, 2304
    buffer_load_dword v85, v77, s[44:47], s84 offen sc1
    s_add_u32 s84, s84, 2304
    buffer_load_dword v86, v77, s[44:47], s84 offen sc1
    s_add_u32 s84, s84, 2304
    buffer_load_dword v87, v77, s[44:47], s84 offen sc1
    s_add_u32 s84, s84, 2304
    buffer_load_dword v88, v77, s[44:47], s84 offen sc1
    s_add_u32 s84, s84, 2304
    buffer_load_dword v89, v77, s[44:47], s84 offen sc1
    s_add_u32 s84, s84, 2304
    buffer_load_dword v90, v77, s[44:47], s84 offen sc1
    s_add_u32 s84, s84, 2304
    buffer_load_dword v91, v77, s[44:47], s84 offen sc1
    s_add_u32 s84, s84, 2304
    buffer_load_dword v92, v77, s[44:47], s84 offen sc1
    s_add_u32 s84, s84, 2304
    buffer_load_dword v93, v77, s[44:47], s84 offen sc1
    s_add_u32 s84, s84, 2304
    buffer_load_dword v94, v77, s[44:47], s84 offen sc1
    s_add_u32 s84, s84, 2304
    buffer_load_dword v95, v77, s[44:47], s84 offen sc1
    s_add_u32 s84, s84, 2304
    buffer_load_dword v96, v77, s[44:47], s84 offen sc1
    s_add_u32 s84, s84, 2304
    buffer_load_dword v97, v77, s[44:47], s84 offen sc1
    s_add_u32 s84, s84, 2304
    buffer_load_dword v98, v77, s[44:47], s84 offen sc1
    s_add_u32 s84, s84, 2304
    buffer_load_dword v99, v77, s[44:47], s84 offen sc1
    s_waitcnt vmcnt(0)
    v_max3_u32 v100, v84, v85, v86
    v_max3_u32 v100, v100, v87, v88
    v_max3_u32 v100, v100, v89, v90
    v_max3_u32 v100, v100, v91, v92
    v_max3_u32 v100, v100, v93, v94
    v_max3_u32 v100, v100, v95, v96
    v_max3_u32 v100, v100, v97, v98
    v_max_u32 v100, v100, v99
    v_cmp_eq_u32 vcc, -1, v100
    s_nop 0
    s_cbranch_vccz L_pdf_16
    s_add_u32 s80, s80, 1
    s_cmp_lt_u32 s80, 200000
    s_cbranch_scc1 L_pollf_15
L_pdf_16:
    v_add_f32 v84, v84, v85
    v_add_f32 v86, v86, v87
    v_add_f32 v88, v88, v89
    v_add_f32 v90, v90, v91
    v_add_f32 v92, v92, v93
    v_add_f32 v94, v94, v95
    v_add_f32 v96, v96, v97
    v_add_f32 v98, v98, v99
    v_add_f32 v84, v84, v86
    v_add_f32 v88, v88, v90
    v_add_f32 v92, v92, v94
    v_add_f32 v96, v96, v98
    v_add_f32 v84, v84, v88
    v_add_f32 v92, v92, v96
    v_add_f32 v84, v84, v92
    s_lshl_b32 s7, s3, 8
    v_add_u32 v4, s7, v77
    ds_write_b32 v4, v84 offset:5120
    s_waitcnt lgkmcnt(0)
    s_barrier
    s_cmp_eq_u32 s3, s82
    s_cbranch_scc0 L_mlp_done_14
    ds_read2st64_b32 v[100:101], v77 offset0:20 offset1:21
    ds_read2st64_b32 v[102:103], v77 offset0:22 offset1:23
    ds_read2st64_b32 v[104:105], v77 offset0:24 offset1:25
    ds_read2st64_b32 v[106:107], v77 offset0:26 offset1:27
    ds_read_b32 v108, v77 offset:7168
    s_lshl_b32 s7, s82, 7
    v_lshl_add_u32 v4, v1, 1, s7
    s_mov_b32 s64, s36
    s_mov_b32 s65, s37
    s_mov_b32 s66, 1152
    s_mov_b32 s67, 0x20000
    s_waitcnt lgkmcnt(0)
    v_add_f32 v100, v100, v101
    v_add_f32 v102, v102, v103
    v_add_f32 v104, v104, v105
    v_add_f32 v106, v106, v107
    v_add_f32 v100, v100, v102
    v_add_f32 v104, v104, v106
    v_add_f32 v100, v100, v108
    v_add_f32 v100, v100, v104
    v_cvt_pk_bf16_f32 v100, 0, v100
    v_mul_f32 v100, v100, v76
    v_cvt_pk_bf16_f32 v100, 0, v100
    v_add_f32 v100, v100, v81
    v_cvt_pk_bf16_f32 v100, v100, v100
    buffer_store_short v100, v4, s[64:67], 0 offen
    s_cmp_eq_u32 s82, 0
    s_cbranch_scc0 L_mlp_done_14
    v_mov_b32 v4, s95
    v_lshlrev_b32 v5, 2, v1
    s_mov_b32 s7, 0x10f000
    s_mov_b32 exec_lo, 0xffffffff
    s_mov_b32 exec_hi, 0x0
    buffer_store_dword v4, v5, s[44:47], s7 offen sc1
L_mlp_done_14:
    s_endpgm
L_clean:
    s_getpc_b64 s[8:9]
L_pc_17:
    s_bfe_u32 s7, s2, 0x30003
    s_mul_i32 s7, s7, 2048
    s_sub_u32 s8, s8, L_pc_17-adaLN_cond__gqa_block_cached__dense_activation_silu__decode_kernel
    s_subb_u32 s9, s9, 0
    v_lshlrev_b32 v8, 4, v1
    v_add_u32 v9, s7, v8
    s_add_u32 s7, s7, 0x400
    v_min_u32 v9, L_end-adaLN_cond__gqa_block_cached__dense_activation_silu__decode_kernel-16, v9
    global_load_dwordx4 v[12:15], v9, s[8:9]
    v_add_u32 v9, s7, v8
    s_add_u32 s7, s7, 0x400
    v_min_u32 v9, L_end-adaLN_cond__gqa_block_cached__dense_activation_silu__decode_kernel-16, v9
    global_load_dwordx4 v[16:19], v9, s[8:9]
    v_mov_b32 v156, 0
    v_mov_b32 v157, 0
    v_mov_b32 v158, 0
    v_mov_b32 v159, 0
    v_lshlrev_b32 v5, 4, v1
    v_lshlrev_b32 v4, 2, v1
    ds_write_b32 v4, v156 offset:2560
    s_waitcnt lgkmcnt(0)
    s_add_u32 s8, s40, 0x10f000
    s_addc_u32 s9, s41, 0
    s_load_dword s94, s[8:9], 0
    s_mov_b32 s44, s40
    s_mov_b32 s45, s41
    s_mov_b32 s46, 1114112
    s_mov_b32 s47, 0x20000
    s_mul_i32 s85, s4, 2816
    s_movk_i32 s86, 2816
    v_mov_b32 v156, -1
    v_mov_b32 v157, -1
    v_mov_b32 v158, -1
    v_mov_b32 v159, -1
    buffer_store_dwordx4 v[156:159], v5, s[44:47], s85 offen offset:1024 sc1
    s_mov_b32 exec_lo, 0xffffffff
    s_mov_b32 exec_hi, 0xff
    buffer_store_dwordx4 v[156:159], v5, s[44:47], s85 offen offset:2048 sc1
    s_mov_b64 exec, -1
    s_cmp_eq_u32 s81, 2
    s_cbranch_scc0 L_noclr_18
    s_mul_i32 s7, s82, 2304
    s_add_u32 s7, s7, 0xba000
    buffer_store_dwordx4 v[156:159], v5, s[44:47], s7 offen offset:0 sc1
    buffer_store_dwordx4 v[156:159], v5, s[44:47], s7 offen offset:1024 sc1
    s_mov_b32 exec_lo, 0xffff
    s_mov_b32 exec_hi, 0x0
    buffer_store_dwordx4 v[156:159], v5, s[44:47], s7 offen offset:2048 sc1
    s_mov_b64 exec, -1
L_noclr_18:
    s_cmp_eq_u32 s81, 1
    s_cbranch_scc0 L_noclr2_19
    s_mul_i32 s7, s14, 384
    s_add_u32 s7, s7, 0xb0000
    s_mov_b32 exec_lo, 0xffffff
    s_mov_b32 exec_hi, 0x0
    buffer_store_dwordx4 v[156:159], v5, s[44:47], s7 offen sc1
    s_mov_b64 exec, -1
L_noclr2_19:
    s_sub_u32 s8, 6, s6
    s_lshl_b32 s8, s8, 4
    s_add_u32 s8, s8, s5
    s_cmp_lt_u32 s8, 18
    s_cbranch_scc0 L_skipclr
    s_lshl_b32 s7, s8, 9
    s_add_u32 s7, s7, 0x10b000
    s_mov_b32 exec_lo, 0xffffffff
    s_mov_b32 exec_hi, 0x0
    buffer_store_dwordx4 v[156:159], v5, s[44:47], s7 offen sc1
    s_mov_b64 exec, -1
L_skipclr:
    s_barrier
    s_waitcnt vmcnt(0) lgkmcnt(0)
    s_mul_i32 s95, s94, 0x9e3779b1
    s_add_u32 s95, s95, 0x7f4a7c15
    v_mov_b32 v4, s95
    v_lshlrev_b32 v5, 2, v1
    s_mov_b32 exec_lo, 0xffffffff
    s_mov_b32 exec_hi, 0x0
    buffer_store_dword v4, v5, s[44:47], s85 offen offset:2688 sc1
    s_cmp_eq_u32 s6, 6
    s_cbranch_scc0 L_noagg_20
    s_mov_b64 exec, -1
    s_lshl_b32 s7, s5, 4
    v_add_u32 v4, s7, v1
    v_mul_u32_u24 v4, s86, v4
    s_mov_b32 exec_lo, 0xffff
    s_mov_b32 exec_hi, 0x0
    s_mov_b32 s80, 0
L_pollagg_21:
    buffer_load_dword v8, v4, s[44:47], 0 offen offset:2688 sc1
    s_sleep 8
    s_waitcnt vmcnt(0)
    v_xor_b32 v9, s95, v8
    v_cmp_ne_u32 vcc, 0, v9
    s_nop 0
    s_cbranch_vccz L_pdagg_22
    s_add_u32 s80, s80, 1
    s_cmp_lt_u32 s80, 200000
    s_cbranch_scc1 L_pollagg_21
L_pdagg_22:
    s_mov_b64 exec, -1
    v_mov_b32 v4, s95
    s_lshl_b32 s7, s5, 7
    s_add_u32 s7, s7, 0x10e000
    s_mov_b32 exec_lo, 0xffffffff
    s_mov_b32 exec_hi, 0x0
    buffer_store_dword v4, v5, s[44:47], s7 offen sc1
L_noagg_20:
    s_endpgm
L_mod:
    s_setprio 2
    s_waitcnt lgkmcnt(0)
    s_add_u32 s8, s40, 0x10f000
    s_addc_u32 s9, s41, 0
    s_load_dword s94, s[8:9], 0
    s_mov_b32 s64, s32
    s_mov_b32 s65, s33
    s_mov_b32 s66, 1152
    s_mov_b32 s67, 0x20000
    s_and_b32 s7, s4, 7
    s_mul_i32 s7, s7, 144
    v_lshlrev_b32 v4, 3, v1
    buffer_load_dwordx2 v[88:89], v4, s[64:67], s7 offen
    s_cmp_lt_u32 s4, 216
    s_cbranch_scc0 L_nomod_23
    s_and_b32 s7, s4, 7
    s_mul_i32 s7, s7, 497664
    s_lshr_b32 s10, s4, 3
    s_lshl_b32 s10, s10, 8
    s_add_u32 s7, s7, s10
    s_add_u32 s52, s34, s7
    s_addc_u32 s53, s35, 0
    s_sub_u32 s54, 3981312, s7
    s_mov_b32 s55, 0x20000
    s_movk_i32 s7, 0x1b00
    v_mul_u32_u24 v4, s7, v2
    v_lshl_add_u32 v4, v3, 4, v4
    s_mov_b32 s84, 0
    buffer_load_dwordx4 v[8:11], v4, s[52:55], s84 offen
    s_mov_b32 s84, 27648
    buffer_load_dwordx4 v[12:15], v4, s[52:55], s84 offen
    s_mov_b32 s84, 55296
    buffer_load_dwordx4 v[16:19], v4, s[52:55], s84 offen
    s_mov_b32 s84, 82944
    buffer_load_dwordx4 v[20:23], v4, s[52:55], s84 offen
    s_mov_b32 s84, 110592
    buffer_load_dwordx4 v[24:27], v4, s[52:55], s84 offen
    s_mov_b32 s84, 138240
    buffer_load_dwordx4 v[28:31], v4, s[52:55], s84 offen
    s_mov_b32 s84, 165888
    buffer_load_dwordx4 v[32:35], v4, s[52:55], s84 offen
    s_mov_b32 s84, 193536
    buffer_load_dwordx4 v[36:39], v4, s[52:55], s84 offen
    s_mov_b32 s84, 221184
    buffer_load_dwordx4 v[40:43], v4, s[52:55], s84 offen
    s_mov_b32 s84, 248832
    buffer_load_dwordx4 v[44:47], v4, s[52:55], s84 offen
    s_mov_b32 s84, 276480
    buffer_load_dwordx4 v[48:51], v4, s[52:55], s84 offen
    s_mov_b32 s84, 304128
    buffer_load_dwordx4 v[52:55], v4, s[52:55], s84 offen
    s_mov_b32 s84, 331776
    buffer_load_dwordx4 v[56:59], v4, s[52:55], s84 offen
    s_mov_b32 s84, 359424
    buffer_load_dwordx4 v[60:63], v4, s[52:55], s84 offen
    s_mov_b32 s84, 387072
    buffer_load_dwordx4 v[64:67], v4, s[52:55], s84 offen
    s_mov_b32 s84, 414720
    buffer_load_dwordx4 v[68:71], v4, s[52:55], s84 offen
    s_mov_b32 s84, 442368
    buffer_load_dwordx4 v[72:75], v4, s[52:55], s84 offen
    s_mov_b32 s84, 470016
    buffer_load_dwordx4 v[76:79], v4, s[52:55], s84 offen
    s_barrier
    s_mov_b32 s44, s40
    s_mov_b32 s45, s41
    s_mov_b32 s46, 1114112
    s_mov_b32 s47, 0x20000
    s_mul_i32 s85, s4, 2816
    s_movk_i32 s86, 2816
    s_mov_b32 s72, 0x3030303
    s_mov_b32 s73, 0x3030303
    s_mov_b32 s74, 0xc0c0c0c
    s_mov_b32 s75, 0xc0c0c0c
    s_mov_b32 s76, 0x30303030
    s_mov_b32 s77, 0x30303030
    s_mov_b32 s78, 0xc0c0c0c0
    s_mov_b32 s79, 0xc0c0c0c0
    v_and_b32 v162, 1, v1
    v_cmp_eq_u32 vcc, 1, v162
    v_mov_b32 v162, 0xffff
    v_mov_b32 v163, 0xffff0000
    v_cndmask_b32 v162, v162, v163, vcc
    v_cmp_gt_u32 vcc, 8, v3
    s_nop 1
    v_cndmask_b32 v162, 0, v162, vcc
    v_lshlrev_b32 v163, 2, v2
    v_lshlrev_b32 v164, 4, v1
    s_waitcnt vmcnt(18)
    v_and_b32 v155, 0xffff0000, v88
    v_lshlrev_b32 v154, 16, v88
    v_and_b32 v157, 0xffff0000, v89
    v_lshlrev_b32 v156, 16, v89
    v_mul_f32 v158, 0xbfb8aa3b, v154
    v_mul_f32 v159, 0xbfb8aa3b, v155
    v_mul_f32 v160, 0xbfb8aa3b, v156
    v_mul_f32 v161, 0xbfb8aa3b, v157
    v_exp_f32 v158, v158
    v_exp_f32 v159, v159
    v_exp_f32 v160, v160
    v_exp_f32 v161, v161
    v_add_f32 v158, 1.0, v158
    v_add_f32 v159, 1.0, v159
    v_add_f32 v160, 1.0, v160
    v_add_f32 v161, 1.0, v161
    v_rcp_f32 v158, v158
    v_rcp_f32 v159, v159
    v_rcp_f32 v160, v160
    v_rcp_f32 v161, v161
    v_mul_f32 v154, v154, v158
    v_mul_f32 v155, v155, v159
    v_mul_f32 v156, v156, v160
    v_mul_f32 v157, v157, v161
    v_cvt_pk_bf16_f32 v154, v154, v154
    v_cvt_pk_bf16_f32 v155, v155, v155
    v_cvt_pk_bf16_f32 v156, v156, v156
    v_cvt_pk_bf16_f32 v157, v157, v157
    ds_write_b128 v164, v[154:157] offset:512
    s_waitcnt vmcnt(0) lgkmcnt(0)
    s_mul_i32 s95, s94, 0x9e3779b1
    s_add_u32 s95, s95, 0x7f4a7c15
    ds_read_b32 v92, v163 offset:512
    ds_read_b32 v93, v163 offset:528
    ds_read_b32 v94, v163 offset:544
    ds_read_b32 v95, v163 offset:560
    ds_read_b32 v96, v163 offset:576
    ds_read_b32 v97, v163 offset:592
    ds_read_b32 v98, v163 offset:608
    ds_read_b32 v99, v163 offset:624
    ds_read_b32 v100, v163 offset:640
    ds_read_b32 v101, v163 offset:656
    ds_read_b32 v102, v163 offset:672
    ds_read_b32 v103, v163 offset:688
    ds_read_b32 v104, v163 offset:704
    ds_read_b32 v105, v163 offset:720
    ds_read_b32 v106, v163 offset:736
    ds_read_b32 v107, v163 offset:752
    ds_read_b32 v108, v163 offset:768
    ds_read_b32 v109, v163 offset:784
    s_waitcnt lgkmcnt(12)
    v_and_b32 v92, v92, v162
    v_cndmask_b32 v110, 0, v92, s[72:73]
    v_cndmask_b32 v111, 0, v92, s[74:75]
    v_cndmask_b32 v112, 0, v92, s[76:77]
    v_cndmask_b32 v113, 0, v92, s[78:79]
    s_nop 1
    v_mfma_f32_16x16x32_bf16 v[118:121], v[110:113], v[8:11], 0
    v_and_b32 v93, v93, v162
    v_cndmask_b32 v114, 0, v93, s[72:73]
    v_cndmask_b32 v115, 0, v93, s[74:75]
    v_cndmask_b32 v116, 0, v93, s[76:77]
    v_cndmask_b32 v117, 0, v93, s[78:79]
    s_nop 1
    v_mfma_f32_16x16x32_bf16 v[118:121], v[114:117], v[12:15], v[118:121]
    v_and_b32 v94, v94, v162
    v_cndmask_b32 v110, 0, v94, s[72:73]
    v_cndmask_b32 v111, 0, v94, s[74:75]
    v_cndmask_b32 v112, 0, v94, s[76:77]
    v_cndmask_b32 v113, 0, v94, s[78:79]
    s_nop 1
    v_mfma_f32_16x16x32_bf16 v[118:121], v[110:113], v[16:19], v[118:121]
    v_and_b32 v95, v95, v162
    v_cndmask_b32 v114, 0, v95, s[72:73]
    v_cndmask_b32 v115, 0, v95, s[74:75]
    v_cndmask_b32 v116, 0, v95, s[76:77]
    v_cndmask_b32 v117, 0, v95, s[78:79]
    s_nop 1
    v_mfma_f32_16x16x32_bf16 v[118:121], v[114:117], v[20:23], v[118:121]
    v_and_b32 v96, v96, v162
    v_cndmask_b32 v110, 0, v96, s[72:73]
    v_cndmask_b32 v111, 0, v96, s[74:75]
    v_cndmask_b32 v112, 0, v96, s[76:77]
    v_cndmask_b32 v113, 0, v96, s[78:79]
    s_nop 1
    v_mfma_f32_16x16x32_bf16 v[118:121], v[110:113], v[24:27], v[118:121]
    v_and_b32 v97, v97, v162
    v_cndmask_b32 v114, 0, v97, s[72:73]
    v_cndmask_b32 v115, 0, v97, s[74:75]
    v_cndmask_b32 v116, 0, v97, s[76:77]
    v_cndmask_b32 v117, 0, v97, s[78:79]
    s_nop 1
    v_mfma_f32_16x16x32_bf16 v[118:121], v[114:117], v[28:31], v[118:121]
    s_waitcnt lgkmcnt(6)
    v_and_b32 v98, v98, v162
    v_cndmask_b32 v110, 0, v98, s[72:73]
    v_cndmask_b32 v111, 0, v98, s[74:75]
    v_cndmask_b32 v112, 0, v98, s[76:77]
    v_cndmask_b32 v113, 0, v98, s[78:79]
    s_nop 1
    v_mfma_f32_16x16x32_bf16 v[118:121], v[110:113], v[32:35], v[118:121]
    v_and_b32 v99, v99, v162
    v_cndmask_b32 v114, 0, v99, s[72:73]
    v_cndmask_b32 v115, 0, v99, s[74:75]
    v_cndmask_b32 v116, 0, v99, s[76:77]
    v_cndmask_b32 v117, 0, v99, s[78:79]
    s_nop 1
    v_mfma_f32_16x16x32_bf16 v[118:121], v[114:117], v[36:39], v[118:121]
    v_and_b32 v100, v100, v162
    v_cndmask_b32 v110, 0, v100, s[72:73]
    v_cndmask_b32 v111, 0, v100, s[74:75]
    v_cndmask_b32 v112, 0, v100, s[76:77]
    v_cndmask_b32 v113, 0, v100, s[78:79]
    s_nop 1
    v_mfma_f32_16x16x32_bf16 v[118:121], v[110:113], v[40:43], v[118:121]
    v_and_b32 v101, v101, v162
    v_cndmask_b32 v114, 0, v101, s[72:73]
    v_cndmask_b32 v115, 0, v101, s[74:75]
    v_cndmask_b32 v116, 0, v101, s[76:77]
    v_cndmask_b32 v117, 0, v101, s[78:79]
    s_nop 1
    v_mfma_f32_16x16x32_bf16 v[118:121], v[114:117], v[44:47], v[118:121]
    v_and_b32 v102, v102, v162
    v_cndmask_b32 v110, 0, v102, s[72:73]
    v_cndmask_b32 v111, 0, v102, s[74:75]
    v_cndmask_b32 v112, 0, v102, s[76:77]
    v_cndmask_b32 v113, 0, v102, s[78:79]
    s_nop 1
    v_mfma_f32_16x16x32_bf16 v[118:121], v[110:113], v[48:51], v[118:121]
    v_and_b32 v103, v103, v162
    v_cndmask_b32 v114, 0, v103, s[72:73]
    v_cndmask_b32 v115, 0, v103, s[74:75]
    v_cndmask_b32 v116, 0, v103, s[76:77]
    v_cndmask_b32 v117, 0, v103, s[78:79]
    s_nop 1
    v_mfma_f32_16x16x32_bf16 v[118:121], v[114:117], v[52:55], v[118:121]
    s_waitcnt lgkmcnt(0)
    v_and_b32 v104, v104, v162
    v_cndmask_b32 v110, 0, v104, s[72:73]
    v_cndmask_b32 v111, 0, v104, s[74:75]
    v_cndmask_b32 v112, 0, v104, s[76:77]
    v_cndmask_b32 v113, 0, v104, s[78:79]
    s_nop 1
    v_mfma_f32_16x16x32_bf16 v[118:121], v[110:113], v[56:59], v[118:121]
    v_and_b32 v105, v105, v162
    v_cndmask_b32 v114, 0, v105, s[72:73]
    v_cndmask_b32 v115, 0, v105, s[74:75]
    v_cndmask_b32 v116, 0, v105, s[76:77]
    v_cndmask_b32 v117, 0, v105, s[78:79]
    s_nop 1
    v_mfma_f32_16x16x32_bf16 v[118:121], v[114:117], v[60:63], v[118:121]
    v_and_b32 v106, v106, v162
    v_cndmask_b32 v110, 0, v106, s[72:73]
    v_cndmask_b32 v111, 0, v106, s[74:75]
    v_cndmask_b32 v112, 0, v106, s[76:77]
    v_cndmask_b32 v113, 0, v106, s[78:79]
    s_nop 1
    v_mfma_f32_16x16x32_bf16 v[118:121], v[110:113], v[64:67], v[118:121]
    v_and_b32 v107, v107, v162
    v_cndmask_b32 v114, 0, v107, s[72:73]
    v_cndmask_b32 v115, 0, v107, s[74:75]
    v_cndmask_b32 v116, 0, v107, s[76:77]
    v_cndmask_b32 v117, 0, v107, s[78:79]
    s_nop 1
    v_mfma_f32_16x16x32_bf16 v[118:121], v[114:117], v[68:71], v[118:121]
    v_and_b32 v108, v108, v162
    v_cndmask_b32 v110, 0, v108, s[72:73]
    v_cndmask_b32 v111, 0, v108, s[74:75]
    v_cndmask_b32 v112, 0, v108, s[76:77]
    v_cndmask_b32 v113, 0, v108, s[78:79]
    s_nop 1
    v_mfma_f32_16x16x32_bf16 v[118:121], v[110:113], v[72:75], v[118:121]
    v_and_b32 v109, v109, v162
    v_cndmask_b32 v114, 0, v109, s[72:73]
    v_cndmask_b32 v115, 0, v109, s[74:75]
    v_cndmask_b32 v116, 0, v109, s[76:77]
    v_cndmask_b32 v117, 0, v109, s[78:79]
    s_nop 1
    v_mfma_f32_16x16x32_bf16 v[118:121], v[114:117], v[76:79], v[118:121]
    s_nop 7
    v_permlane32_swap_b32 v118, v120
    v_permlane32_swap_b32 v119, v121
    v_mov_b32 v110, v118
    v_mov_b32 v111, s95
    v_mov_b32 v112, v119
    v_mov_b32 v113, s95
    buffer_store_dwordx4 v[110:113], v164, s[44:47], s85 offen offset:0 sc1
    s_endpgm
L_nomod_23:
    s_barrier
    s_endpgm
L_ctrl:
    s_setprio 3
    s_waitcnt lgkmcnt(0)
    s_add_u32 s8, s40, 0x10f000
    s_addc_u32 s9, s41, 0
    s_load_dword s94, s[8:9], 0
    s_mov_b32 s48, s16
    s_mov_b32 s49, s17
    s_mov_b32 s50, 1152
    s_mov_b32 s51, 0x20000
    s_lshr_b32 s87, s6, 1
    s_mul_i32 s87, s87, 72
    s_lshl_b32 s7, s87, 1
    v_lshlrev_b32 v4, 3, v1
    buffer_load_dwordx2 v[90:91], v4, s[48:51], s7 offen
    v_lshlrev_b32 v5, 5, v1
    buffer_load_dwordx4 v[80:83], v5, s[48:51], 0 offen
    buffer_load_dwordx4 v[84:87], v5, s[48:51], 0 offen offset:16
    s_lshl_b32 s7, s87, 13
    s_lshl_b32 s10, s5, 9
    s_add_u32 s7, s7, s10
    s_and_b32 s10, s6, 1
    s_lshl_b32 s10, s10, 8
    s_add_u32 s7, s7, s10
    s_add_u32 s52, s22, s7
    s_addc_u32 s53, s23, 0
    s_sub_u32 s54, 4718592, s7
    s_mov_b32 s55, 0x20000
    v_lshlrev_b32 v4, 13, v2
    v_lshl_add_u32 v4, v3, 4, v4
    s_mov_b32 s84, 0x0
    buffer_load_dwordx4 v[8:11], v4, s[52:55], s84 offen
    s_mov_b32 s84, 0x8000
    buffer_load_dwordx4 v[12:15], v4, s[52:55], s84 offen
    s_mov_b32 s84, 0x10000
    buffer_load_dwordx4 v[16:19], v4, s[52:55], s84 offen
    s_mov_b32 s84, 0x18000
    buffer_load_dwordx4 v[20:23], v4, s[52:55], s84 offen
    s_mov_b32 s84, 0x20000
    buffer_load_dwordx4 v[24:27], v4, s[52:55], s84 offen
    s_mov_b32 s84, 0x28000
    buffer_load_dwordx4 v[28:31], v4, s[52:55], s84 offen
    s_mov_b32 s84, 0x30000
    buffer_load_dwordx4 v[32:35], v4, s[52:55], s84 offen
    s_mov_b32 s84, 0x38000
    buffer_load_dwordx4 v[36:39], v4, s[52:55], s84 offen
    s_mov_b32 s84, 0x40000
    buffer_load_dwordx4 v[40:43], v4, s[52:55], s84 offen
    s_mov_b32 s84, 0x48000
    buffer_load_dwordx4 v[44:47], v4, s[52:55], s84 offen
    s_mov_b32 s84, 0x50000
    buffer_load_dwordx4 v[48:51], v4, s[52:55], s84 offen
    s_mov_b32 s84, 0x58000
    buffer_load_dwordx4 v[52:55], v4, s[52:55], s84 offen
    s_mov_b32 s84, 0x60000
    buffer_load_dwordx4 v[56:59], v4, s[52:55], s84 offen
    s_mov_b32 s84, 0x68000
    buffer_load_dwordx4 v[60:63], v4, s[52:55], s84 offen
    s_mov_b32 s84, 0x70000
    buffer_load_dwordx4 v[64:67], v4, s[52:55], s84 offen
    s_mov_b32 s84, 0x78000
    buffer_load_dwordx4 v[68:71], v4, s[52:55], s84 offen
    s_mov_b32 s84, 0x80000
    buffer_load_dwordx4 v[72:75], v4, s[52:55], s84 offen
    s_mov_b32 s84, 0x88000
    buffer_load_dwordx4 v[76:79], v4, s[52:55], s84 offen
    s_barrier
    s_mov_b32 s44, s40
    s_mov_b32 s45, s41
    s_mov_b32 s46, 1114112
    s_mov_b32 s47, 0x20000
    s_mul_i32 s85, s4, 2816
    s_movk_i32 s86, 2816
    s_mov_b32 s72, 0x3030303
    s_mov_b32 s73, 0x3030303
    s_mov_b32 s74, 0xc0c0c0c
    s_mov_b32 s75, 0xc0c0c0c
    s_mov_b32 s76, 0x30303030
    s_mov_b32 s77, 0x30303030
    s_mov_b32 s78, 0xc0c0c0c0
    s_mov_b32 s79, 0xc0c0c0c0
    v_and_b32 v162, 1, v1
    v_cmp_eq_u32 vcc, 1, v162
    v_mov_b32 v162, 0xffff
    v_mov_b32 v163, 0xffff0000
    v_cndmask_b32 v162, v162, v163, vcc
    v_cmp_gt_u32 vcc, 8, v3
    s_nop 1
    v_cndmask_b32 v162, 0, v162, vcc
    v_lshlrev_b32 v163, 2, v2
    v_lshlrev_b32 v164, 4, v1
    s_waitcnt vmcnt(18) lgkmcnt(0)
    s_mul_i32 s95, s94, 0x9e3779b1
    s_add_u32 s95, s95, 0x7f4a7c15
    v_mov_b32 v154, 0
    v_mov_b32 v155, 0
    v_and_b32 v157, 0xffff0000, v80
    v_lshlrev_b32 v156, 16, v80
    v_add_f32 v154, v154, v156
    v_fmac_f32 v155, v156, v156
    v_add_f32 v154, v154, v157
    v_fmac_f32 v155, v157, v157
    v_and_b32 v157, 0xffff0000, v81
    v_lshlrev_b32 v156, 16, v81
    v_add_f32 v154, v154, v156
    v_fmac_f32 v155, v156, v156
    v_add_f32 v154, v154, v157
    v_fmac_f32 v155, v157, v157
    v_and_b32 v157, 0xffff0000, v82
    v_lshlrev_b32 v156, 16, v82
    v_add_f32 v154, v154, v156
    v_fmac_f32 v155, v156, v156
    v_add_f32 v154, v154, v157
    v_fmac_f32 v155, v157, v157
    v_and_b32 v157, 0xffff0000, v83
    v_lshlrev_b32 v156, 16, v83
    v_add_f32 v154, v154, v156
    v_fmac_f32 v155, v156, v156
    v_add_f32 v154, v154, v157
    v_fmac_f32 v155, v157, v157
    v_and_b32 v157, 0xffff0000, v84
    v_lshlrev_b32 v156, 16, v84
    v_add_f32 v154, v154, v156
    v_fmac_f32 v155, v156, v156
    v_add_f32 v154, v154, v157
    v_fmac_f32 v155, v157, v157
    v_and_b32 v157, 0xffff0000, v85
    v_lshlrev_b32 v156, 16, v85
    v_add_f32 v154, v154, v156
    v_fmac_f32 v155, v156, v156
    v_add_f32 v154, v154, v157
    v_fmac_f32 v155, v157, v157
    v_and_b32 v157, 0xffff0000, v86
    v_lshlrev_b32 v156, 16, v86
    v_add_f32 v154, v154, v156
    v_fmac_f32 v155, v156, v156
    v_add_f32 v154, v154, v157
    v_fmac_f32 v155, v157, v157
    v_and_b32 v157, 0xffff0000, v87
    v_lshlrev_b32 v156, 16, v87
    v_add_f32 v154, v154, v156
    v_fmac_f32 v155, v156, v156
    v_add_f32 v154, v154, v157
    v_fmac_f32 v155, v157, v157
    s_nop 0
    v_add_f32_dpp v154, v154, v154 row_ror:8 row_mask:0xf bank_mask:0xf
    v_add_f32_dpp v155, v155, v155 row_ror:8 row_mask:0xf bank_mask:0xf
    s_nop 0
    v_add_f32_dpp v154, v154, v154 row_ror:4 row_mask:0xf bank_mask:0xf
    v_add_f32_dpp v155, v155, v155 row_ror:4 row_mask:0xf bank_mask:0xf
    s_nop 0
    v_add_f32_dpp v154, v154, v154 row_ror:2 row_mask:0xf bank_mask:0xf
    v_add_f32_dpp v155, v155, v155 row_ror:2 row_mask:0xf bank_mask:0xf
    s_nop 0
    v_add_f32_dpp v154, v154, v154 row_ror:1 row_mask:0xf bank_mask:0xf
    v_add_f32_dpp v155, v155, v155 row_ror:1 row_mask:0xf bank_mask:0xf
    v_mov_b32 v156, v154
    v_mov_b32 v157, v155
    s_nop 0
    v_permlane16_swap_b32 v154, v156
    v_permlane16_swap_b32 v155, v157
    v_add_f32 v154, v154, v156
    v_add_f32 v155, v155, v157
    v_mov_b32 v156, v154
    v_mov_b32 v157, v155
    s_nop 0
    v_permlane32_swap_b32 v154, v156
    v_permlane32_swap_b32 v155, v157
    v_add_f32 v154, v154, v156
    v_add_f32 v155, v155, v157
    v_mul_f32 v154, 0x3ae38e39, v154
    v_mul_f32 v155, 0x3ae38e39, v155
    v_fma_f32 v155, -v154, v154, v155
    v_cvt_pk_bf16_f32 v80, 0, v154
    v_max_f32 v155, 0, v155
    v_cvt_pk_bf16_f32 v155, 0, v155
    v_add_f32 v155, 0x3727c5ac, v155
    v_cvt_pk_bf16_f32 v155, 0, v155
    v_sqrt_f32 v155, v155
    s_nop 0
    v_cvt_pk_bf16_f32 v155, 0, v155
    v_rcp_f32 v81, v155
    v_and_b32 v4, 31, v1
    v_lshl_add_u32 v4, v4, 2, s87
    v_cmp_lt_u32 vcc, 31, v1
    v_mov_b32 v5, 576
    s_nop 0
    v_cndmask_b32 v5, 0, v5, vcc
    v_add_u32 v4, v4, v5
    v_lshrrev_b32 v5, 7, v4
    v_lshlrev_b32 v5, 3, v5
    v_mul_u32_u24 v5, s86, v5
    v_bfe_u32 v156, v4, 3, 4
    v_bfe_u32 v157, v4, 2, 1
    v_lshl_add_u32 v156, v157, 4, v156
    v_lshl_add_u32 v4, v156, 4, v5
    s_lshl_b32 s7, s5, 4
    v_add_u32 v158, s7, v1
    v_mul_u32_u24 v158, s86, v158
    v_mov_b32 v159, s95
    s_mov_b32 s88, 2816
    s_mov_b32 s89, 5632
    s_mov_b32 s90, 8448
    s_mov_b32 s91, 11264
    s_mov_b32 s92, 14080
    s_mov_b32 s93, 16896
    s_mov_b32 s94, 19712
    s_sleep 120
    s_sleep 20
    s_mov_b32 exec_lo, 0x3ffff
    s_mov_b32 exec_hi, 0x3ffff
    s_mov_b32 s80, 0
L_pollm_24:
    buffer_load_dwordx4 v[92:95], v4, s[44:47], 0 offen offset:0 sc1
    buffer_load_dwordx4 v[96:99], v4, s[44:47], 0 offen offset:512 sc1
    buffer_load_dwordx4 v[100:103], v4, s[44:47], s88 offen offset:0 sc1
    buffer_load_dwordx4 v[104:107], v4, s[44:47], s88 offen offset:512 sc1
    buffer_load_dwordx4 v[108:111], v4, s[44:47], s89 offen offset:0 sc1
    buffer_load_dwordx4 v[112:115], v4, s[44:47], s89 offen offset:512 sc1
    buffer_load_dwordx4 v[116:119], v4, s[44:47], s90 offen offset:0 sc1
    buffer_load_dwordx4 v[120:123], v4, s[44:47], s90 offen offset:512 sc1
    buffer_load_dwordx4 v[124:127], v4, s[44:47], s91 offen offset:0 sc1
    buffer_load_dwordx4 v[128:131], v4, s[44:47], s91 offen offset:512 sc1
    buffer_load_dwordx4 v[132:135], v4, s[44:47], s92 offen offset:0 sc1
    buffer_load_dwordx4 v[136:139], v4, s[44:47], s92 offen offset:512 sc1
    buffer_load_dwordx4 v[140:143], v4, s[44:47], s93 offen offset:0 sc1
    buffer_load_dwordx4 v[144:147], v4, s[44:47], s93 offen offset:512 sc1
    buffer_load_dwordx4 v[148:151], v4, s[44:47], s94 offen offset:0 sc1
    buffer_load_dwordx4 v[152:155], v4, s[44:47], s94 offen offset:512 sc1
    s_mov_b32 exec_lo, 0xffff
    s_mov_b32 exec_hi, 0
    buffer_load_dword v159, v158, s[44:47], 0 offen offset:2688 sc1
    s_mov_b32 exec_lo, 0x3ffff
    s_mov_b32 exec_hi, 0x3ffff
    s_waitcnt vmcnt(0)
    v_xor_b32 v160, s95, v93
    v_xad_u32 v160, v95, s95, v160
    v_xad_u32 v160, v97, s95, v160
    v_xad_u32 v160, v99, s95, v160
    v_xad_u32 v160, v101, s95, v160
    v_xad_u32 v160, v103, s95, v160
    v_xad_u32 v160, v105, s95, v160
    v_xad_u32 v160, v107, s95, v160
    v_xad_u32 v160, v109, s95, v160
    v_xad_u32 v160, v111, s95, v160
    v_xad_u32 v160, v113, s95, v160
    v_xad_u32 v160, v115, s95, v160
    v_xad_u32 v160, v117, s95, v160
    v_xad_u32 v160, v119, s95, v160
    v_xad_u32 v160, v121, s95, v160
    v_xad_u32 v160, v123, s95, v160
    v_xad_u32 v160, v125, s95, v160
    v_xad_u32 v160, v127, s95, v160
    v_xad_u32 v160, v129, s95, v160
    v_xad_u32 v160, v131, s95, v160
    v_xad_u32 v160, v133, s95, v160
    v_xad_u32 v160, v135, s95, v160
    v_xad_u32 v160, v137, s95, v160
    v_xad_u32 v160, v139, s95, v160
    v_xad_u32 v160, v141, s95, v160
    v_xad_u32 v160, v143, s95, v160
    v_xad_u32 v160, v145, s95, v160
    v_xad_u32 v160, v147, s95, v160
    v_xad_u32 v160, v149, s95, v160
    v_xad_u32 v160, v151, s95, v160
    v_xad_u32 v160, v153, s95, v160
    v_xad_u32 v160, v155, s95, v160
    v_xad_u32 v160, v159, s95, v160
    v_cmp_ne_u32 vcc, 0, v160
    s_nop 0
    s_cbranch_vccz L_pdm_25
    s_add_u32 s80, s80, 1
    s_cmp_lt_u32 s80, 200000
    s_cbranch_scc1 L_pollm_24
L_pdm_25:
    s_mov_b64 exec, -1
    v_add_f32 v156, v92, v100
    v_add_f32 v157, v94, v102
    v_add_f32 v158, v96, v104
    v_add_f32 v159, v98, v106
    v_add_f32 v156, v156, v108
    v_add_f32 v157, v157, v110
    v_add_f32 v158, v158, v112
    v_add_f32 v159, v159, v114
    v_add_f32 v156, v156, v116
    v_add_f32 v157, v157, v118
    v_add_f32 v158, v158, v120
    v_add_f32 v159, v159, v122
    v_add_f32 v156, v156, v124
    v_add_f32 v157, v157, v126
    v_add_f32 v158, v158, v128
    v_add_f32 v159, v159, v130
    v_add_f32 v156, v156, v132
    v_add_f32 v157, v157, v134
    v_add_f32 v158, v158, v136
    v_add_f32 v159, v159, v138
    v_add_f32 v156, v156, v140
    v_add_f32 v157, v157, v142
    v_add_f32 v158, v158, v144
    v_add_f32 v159, v159, v146
    v_add_f32 v156, v156, v148
    v_add_f32 v157, v157, v150
    v_add_f32 v158, v158, v152
    v_add_f32 v159, v159, v154
    v_cvt_pk_bf16_f32 v122, 0, v156
    v_cvt_pk_bf16_f32 v123, 0, v157
    v_cvt_pk_bf16_f32 v124, 0, v158
    v_cvt_pk_bf16_f32 v125, 0, v159
    v_mov_b32 v126, v122
    v_mov_b32 v127, v123
    v_mov_b32 v128, v124
    v_mov_b32 v129, v125
    v_permlane32_swap_b32 v122, v126
    v_permlane32_swap_b32 v123, v127
    v_permlane32_swap_b32 v124, v128
    v_permlane32_swap_b32 v125, v129
    v_and_b32 v131, 0xffff0000, v90
    v_lshlrev_b32 v130, 16, v90
    v_and_b32 v133, 0xffff0000, v91
    v_lshlrev_b32 v132, 16, v91
    v_sub_f32 v130, v130, v80
    v_sub_f32 v131, v131, v80
    v_sub_f32 v132, v132, v80
    v_sub_f32 v133, v133, v80
    v_add_f32 v134, 1.0, v126
    v_add_f32 v135, 1.0, v127
    v_add_f32 v136, 1.0, v128
    v_add_f32 v137, 1.0, v129
    v_cvt_pk_bf16_f32 v130, 0, v130
    v_cvt_pk_bf16_f32 v131, 0, v131
    v_cvt_pk_bf16_f32 v132, 0, v132
    v_cvt_pk_bf16_f32 v133, 0, v133
    v_cvt_pk_bf16_f32 v134, 0, v134
    v_cvt_pk_bf16_f32 v135, 0, v135
    v_cvt_pk_bf16_f32 v136, 0, v136
    v_cvt_pk_bf16_f32 v137, 0, v137
    v_mul_f32 v130, v130, v81
    v_mul_f32 v131, v131, v81
    v_mul_f32 v132, v132, v81
    v_mul_f32 v133, v133, v81
    v_cvt_pk_bf16_f32 v130, 0, v130
    v_cvt_pk_bf16_f32 v131, 0, v131
    v_cvt_pk_bf16_f32 v132, 0, v132
    v_cvt_pk_bf16_f32 v133, 0, v133
    v_mul_f32 v130, v130, v134
    v_mul_f32 v131, v131, v135
    v_mul_f32 v132, v132, v136
    v_mul_f32 v133, v133, v137
    v_cvt_pk_bf16_f32 v130, 0, v130
    v_cvt_pk_bf16_f32 v131, 0, v131
    v_cvt_pk_bf16_f32 v132, 0, v132
    v_cvt_pk_bf16_f32 v133, 0, v133
    v_add_f32 v130, v130, v122
    v_add_f32 v131, v131, v123
    v_add_f32 v132, v132, v124
    v_add_f32 v133, v133, v125
    v_cvt_pk_bf16_f32 v130, v130, v130
    v_cvt_pk_bf16_f32 v131, v131, v131
    v_cvt_pk_bf16_f32 v132, v132, v132
    v_cvt_pk_bf16_f32 v133, v133, v133
    ds_write_b128 v164, v[130:133] offset:1536
    s_waitcnt lgkmcnt(0)
    ds_read_b32 v92, v163 offset:1536
    ds_read_b32 v93, v163 offset:1552
    ds_read_b32 v94, v163 offset:1568
    ds_read_b32 v95, v163 offset:1584
    ds_read_b32 v96, v163 offset:1600
    ds_read_b32 v97, v163 offset:1616
    ds_read_b32 v98, v163 offset:1632
    ds_read_b32 v99, v163 offset:1648
    ds_read_b32 v100, v163 offset:1664
    ds_read_b32 v101, v163 offset:1680
    ds_read_b32 v102, v163 offset:1696
    ds_read_b32 v103, v163 offset:1712
    ds_read_b32 v104, v163 offset:1728
    ds_read_b32 v105, v163 offset:1744
    ds_read_b32 v106, v163 offset:1760
    ds_read_b32 v107, v163 offset:1776
    ds_read_b32 v108, v163 offset:1792
    ds_read_b32 v109, v163 offset:1808
    s_waitcnt lgkmcnt(12)
    v_and_b32 v92, v92, v162
    v_cndmask_b32 v110, 0, v92, s[72:73]
    v_cndmask_b32 v111, 0, v92, s[74:75]
    v_cndmask_b32 v112, 0, v92, s[76:77]
    v_cndmask_b32 v113, 0, v92, s[78:79]
    s_nop 1
    v_mfma_f32_16x16x32_bf16 v[118:121], v[110:113], v[8:11], 0
    v_and_b32 v93, v93, v162
    v_cndmask_b32 v114, 0, v93, s[72:73]
    v_cndmask_b32 v115, 0, v93, s[74:75]
    v_cndmask_b32 v116, 0, v93, s[76:77]
    v_cndmask_b32 v117, 0, v93, s[78:79]
    s_nop 1
    v_mfma_f32_16x16x32_bf16 v[118:121], v[114:117], v[12:15], v[118:121]
    v_and_b32 v94, v94, v162
    v_cndmask_b32 v110, 0, v94, s[72:73]
    v_cndmask_b32 v111, 0, v94, s[74:75]
    v_cndmask_b32 v112, 0, v94, s[76:77]
    v_cndmask_b32 v113, 0, v94, s[78:79]
    s_nop 1
    v_mfma_f32_16x16x32_bf16 v[118:121], v[110:113], v[16:19], v[118:121]
    v_and_b32 v95, v95, v162
    v_cndmask_b32 v114, 0, v95, s[72:73]
    v_cndmask_b32 v115, 0, v95, s[74:75]
    v_cndmask_b32 v116, 0, v95, s[76:77]
    v_cndmask_b32 v117, 0, v95, s[78:79]
    s_nop 1
    v_mfma_f32_16x16x32_bf16 v[118:121], v[114:117], v[20:23], v[118:121]
    v_and_b32 v96, v96, v162
    v_cndmask_b32 v110, 0, v96, s[72:73]
    v_cndmask_b32 v111, 0, v96, s[74:75]
    v_cndmask_b32 v112, 0, v96, s[76:77]
    v_cndmask_b32 v113, 0, v96, s[78:79]
    s_nop 1
    v_mfma_f32_16x16x32_bf16 v[118:121], v[110:113], v[24:27], v[118:121]
    v_and_b32 v97, v97, v162
    v_cndmask_b32 v114, 0, v97, s[72:73]
    v_cndmask_b32 v115, 0, v97, s[74:75]
    v_cndmask_b32 v116, 0, v97, s[76:77]
    v_cndmask_b32 v117, 0, v97, s[78:79]
    s_nop 1
    v_mfma_f32_16x16x32_bf16 v[118:121], v[114:117], v[28:31], v[118:121]
    s_waitcnt lgkmcnt(6)
    v_and_b32 v98, v98, v162
    v_cndmask_b32 v110, 0, v98, s[72:73]
    v_cndmask_b32 v111, 0, v98, s[74:75]
    v_cndmask_b32 v112, 0, v98, s[76:77]
    v_cndmask_b32 v113, 0, v98, s[78:79]
    s_nop 1
    v_mfma_f32_16x16x32_bf16 v[118:121], v[110:113], v[32:35], v[118:121]
    v_and_b32 v99, v99, v162
    v_cndmask_b32 v114, 0, v99, s[72:73]
    v_cndmask_b32 v115, 0, v99, s[74:75]
    v_cndmask_b32 v116, 0, v99, s[76:77]
    v_cndmask_b32 v117, 0, v99, s[78:79]
    s_nop 1
    v_mfma_f32_16x16x32_bf16 v[118:121], v[114:117], v[36:39], v[118:121]
    v_and_b32 v100, v100, v162
    v_cndmask_b32 v110, 0, v100, s[72:73]
    v_cndmask_b32 v111, 0, v100, s[74:75]
    v_cndmask_b32 v112, 0, v100, s[76:77]
    v_cndmask_b32 v113, 0, v100, s[78:79]
    s_nop 1
    v_mfma_f32_16x16x32_bf16 v[118:121], v[110:113], v[40:43], v[118:121]
    v_and_b32 v101, v101, v162
    v_cndmask_b32 v114, 0, v101, s[72:73]
    v_cndmask_b32 v115, 0, v101, s[74:75]
    v_cndmask_b32 v116, 0, v101, s[76:77]
    v_cndmask_b32 v117, 0, v101, s[78:79]
    s_nop 1
    v_mfma_f32_16x16x32_bf16 v[118:121], v[114:117], v[44:47], v[118:121]
    v_and_b32 v102, v102, v162
    v_cndmask_b32 v110, 0, v102, s[72:73]
    v_cndmask_b32 v111, 0, v102, s[74:75]
    v_cndmask_b32 v112, 0, v102, s[76:77]
    v_cndmask_b32 v113, 0, v102, s[78:79]
    s_nop 1
    v_mfma_f32_16x16x32_bf16 v[118:121], v[110:113], v[48:51], v[118:121]
    v_and_b32 v103, v103, v162
    v_cndmask_b32 v114, 0, v103, s[72:73]
    v_cndmask_b32 v115, 0, v103, s[74:75]
    v_cndmask_b32 v116, 0, v103, s[76:77]
    v_cndmask_b32 v117, 0, v103, s[78:79]
    s_nop 1
    v_mfma_f32_16x16x32_bf16 v[118:121], v[114:117], v[52:55], v[118:121]
    s_waitcnt lgkmcnt(0)
    v_and_b32 v104, v104, v162
    v_cndmask_b32 v110, 0, v104, s[72:73]
    v_cndmask_b32 v111, 0, v104, s[74:75]
    v_cndmask_b32 v112, 0, v104, s[76:77]
    v_cndmask_b32 v113, 0, v104, s[78:79]
    s_nop 1
    v_mfma_f32_16x16x32_bf16 v[118:121], v[110:113], v[56:59], v[118:121]
    v_and_b32 v105, v105, v162
    v_cndmask_b32 v114, 0, v105, s[72:73]
    v_cndmask_b32 v115, 0, v105, s[74:75]
    v_cndmask_b32 v116, 0, v105, s[76:77]
    v_cndmask_b32 v117, 0, v105, s[78:79]
    s_nop 1
    v_mfma_f32_16x16x32_bf16 v[118:121], v[114:117], v[60:63], v[118:121]
    v_and_b32 v106, v106, v162
    v_cndmask_b32 v110, 0, v106, s[72:73]
    v_cndmask_b32 v111, 0, v106, s[74:75]
    v_cndmask_b32 v112, 0, v106, s[76:77]
    v_cndmask_b32 v113, 0, v106, s[78:79]
    s_nop 1
    v_mfma_f32_16x16x32_bf16 v[118:121], v[110:113], v[64:67], v[118:121]
    v_and_b32 v107, v107, v162
    v_cndmask_b32 v114, 0, v107, s[72:73]
    v_cndmask_b32 v115, 0, v107, s[74:75]
    v_cndmask_b32 v116, 0, v107, s[76:77]
    v_cndmask_b32 v117, 0, v107, s[78:79]
    s_nop 1
    v_mfma_f32_16x16x32_bf16 v[118:121], v[114:117], v[68:71], v[118:121]
    v_and_b32 v108, v108, v162
    v_cndmask_b32 v110, 0, v108, s[72:73]
    v_cndmask_b32 v111, 0, v108, s[74:75]
    v_cndmask_b32 v112, 0, v108, s[76:77]
    v_cndmask_b32 v113, 0, v108, s[78:79]
    s_nop 1
    v_mfma_f32_16x16x32_bf16 v[118:121], v[110:113], v[72:75], v[118:121]
    v_and_b32 v109, v109, v162
    v_cndmask_b32 v114, 0, v109, s[72:73]
    v_cndmask_b32 v115, 0, v109, s[74:75]
    v_cndmask_b32 v116, 0, v109, s[76:77]
    v_cndmask_b32 v117, 0, v109, s[78:79]
    s_nop 1
    v_mfma_f32_16x16x32_bf16 v[118:121], v[114:117], v[76:79], v[118:121]
    v_lshlrev_b32 v4, 5, v3
    v_lshl_add_u32 v4, v2, 4, v4
    s_mov_b32 exec_lo, 0xffffffff
    s_mov_b32 exec_hi, 0x0
    s_nop 3
    buffer_store_dwordx4 v[118:121], v4, s[44:47], s85 offen offset:1024 sc1
    s_mov_b64 exec, -1
    s_sub_u32 s13, 6, s6
    s_lshl_b32 s13, s13, 4
    s_add_u32 s13, s13, s5
    s_cmp_lt_u32 s13, 18
    s_cbranch_scc0 L_nored_26
    s_add_u32 s7, s13, 9
    s_mul_i32 s7, s7, 22528
    v_and_b32 v4, 1, v1
    v_lshrrev_b32 v5, 1, v1
    v_lshl_add_u32 v4, v4, 4, v5
    v_lshl_add_u32 v4, v4, 4, s7
    s_mov_b32 exec_lo, 0xffffffff
    s_mov_b32 exec_hi, 0x0
    s_mov_b32 s80, 0
L_pollb_27:
    buffer_load_dwordx4 v[92:95], v4, s[44:47], 0 offen offset:0 sc1
    buffer_load_dwordx4 v[96:99], v4, s[44:47], 0 offen offset:512 sc1
    buffer_load_dwordx4 v[100:103], v4, s[44:47], s88 offen offset:0 sc1
    buffer_load_dwordx4 v[104:107], v4, s[44:47], s88 offen offset:512 sc1
    buffer_load_dwordx4 v[108:111], v4, s[44:47], s89 offen offset:0 sc1
    buffer_load_dwordx4 v[112:115], v4, s[44:47], s89 offen offset:512 sc1
    buffer_load_dwordx4 v[116:119], v4, s[44:47], s90 offen offset:0 sc1
    buffer_load_dwordx4 v[120:123], v4, s[44:47], s90 offen offset:512 sc1
    buffer_load_dwordx4 v[124:127], v4, s[44:47], s91 offen offset:0 sc1
    buffer_load_dwordx4 v[128:131], v4, s[44:47], s91 offen offset:512 sc1
    buffer_load_dwordx4 v[132:135], v4, s[44:47], s92 offen offset:0 sc1
    buffer_load_dwordx4 v[136:139], v4, s[44:47], s92 offen offset:512 sc1
    buffer_load_dwordx4 v[140:143], v4, s[44:47], s93 offen offset:0 sc1
    buffer_load_dwordx4 v[144:147], v4, s[44:47], s93 offen offset:512 sc1
    buffer_load_dwordx4 v[148:151], v4, s[44:47], s94 offen offset:0 sc1
    buffer_load_dwordx4 v[152:155], v4, s[44:47], s94 offen offset:512 sc1
    s_waitcnt vmcnt(0)
    v_xor_b32 v160, s95, v93
    v_xad_u32 v160, v95, s95, v160
    v_xad_u32 v160, v97, s95, v160
    v_xad_u32 v160, v99, s95, v160
    v_xad_u32 v160, v101, s95, v160
    v_xad_u32 v160, v103, s95, v160
    v_xad_u32 v160, v105, s95, v160
    v_xad_u32 v160, v107, s95, v160
    v_xad_u32 v160, v109, s95, v160
    v_xad_u32 v160, v111, s95, v160
    v_xad_u32 v160, v113, s95, v160
    v_xad_u32 v160, v115, s95, v160
    v_xad_u32 v160, v117, s95, v160
    v_xad_u32 v160, v119, s95, v160
    v_xad_u32 v160, v121, s95, v160
    v_xad_u32 v160, v123, s95, v160
    v_xad_u32 v160, v125, s95, v160
    v_xad_u32 v160, v127, s95, v160
    v_xad_u32 v160, v129, s95, v160
    v_xad_u32 v160, v131, s95, v160
    v_xad_u32 v160, v133, s95, v160
    v_xad_u32 v160, v135, s95, v160
    v_xad_u32 v160, v137, s95, v160
    v_xad_u32 v160, v139, s95, v160
    v_xad_u32 v160, v141, s95, v160
    v_xad_u32 v160, v143, s95, v160
    v_xad_u32 v160, v145, s95, v160
    v_xad_u32 v160, v147, s95, v160
    v_xad_u32 v160, v149, s95, v160
    v_xad_u32 v160, v151, s95, v160
    v_xad_u32 v160, v153, s95, v160
    v_xad_u32 v160, v155, s95, v160
    v_cmp_ne_u32 vcc, 0, v160
    s_nop 0
    s_cbranch_vccz L_pdb_28
    s_add_u32 s80, s80, 1
    s_cmp_lt_u32 s80, 200000
    s_cbranch_scc1 L_pollb_27
L_pdb_28:
    v_add_f32 v156, v92, v100
    v_add_f32 v157, v94, v102
    v_add_f32 v158, v96, v104
    v_add_f32 v159, v98, v106
    v_add_f32 v156, v156, v108
    v_add_f32 v157, v157, v110
    v_add_f32 v158, v158, v112
    v_add_f32 v159, v159, v114
    v_add_f32 v156, v156, v116
    v_add_f32 v157, v157, v118
    v_add_f32 v158, v158, v120
    v_add_f32 v159, v159, v122
    v_add_f32 v156, v156, v124
    v_add_f32 v157, v157, v126
    v_add_f32 v158, v158, v128
    v_add_f32 v159, v159, v130
    v_add_f32 v156, v156, v132
    v_add_f32 v157, v157, v134
    v_add_f32 v158, v158, v136
    v_add_f32 v159, v159, v138
    v_add_f32 v156, v156, v140
    v_add_f32 v157, v157, v142
    v_add_f32 v158, v158, v144
    v_add_f32 v159, v159, v146
    v_add_f32 v156, v156, v148
    v_add_f32 v157, v157, v150
    v_add_f32 v158, v158, v152
    v_add_f32 v159, v159, v154
    v_cvt_pk_bf16_f32 v156, 0, v156
    v_cvt_pk_bf16_f32 v157, 0, v157
    v_cvt_pk_bf16_f32 v158, 0, v158
    v_cvt_pk_bf16_f32 v159, 0, v159
    s_lshl_b32 s7, s13, 9
    s_add_u32 s7, s7, 0x10b000
    buffer_store_dwordx4 v[156:159], v164, s[44:47], s7 offen sc1
    s_mov_b64 exec, -1
L_nored_26:
    v_lshrrev_b32 v4, 5, v1
    s_lshl_b32 s7, s5, 4
    v_add_u32 v4, s7, v4
    v_mul_u32_u24 v4, s86, v4
    v_and_b32 v5, 31, v1
    v_lshl_add_u32 v4, v5, 4, v4
    v_lshlrev_b32 v158, 7, v1
    v_mov_b32 v159, s95
    s_mov_b32 s12, 0x10e000
    s_mov_b32 s88, 5632
    s_mov_b32 s89, 11264
    s_mov_b32 s90, 16896
    s_mov_b32 s91, 22528
    s_mov_b32 s92, 28160
    s_mov_b32 s93, 33792
    s_mov_b32 s94, 39424
    s_sleep 40
    s_mov_b32 s80, 0
L_pollq_29:
    buffer_load_dwordx4 v[122:125], v4, s[44:47], 0 offen offset:1024 sc1
    buffer_load_dwordx4 v[126:129], v4, s[44:47], s88 offen offset:1024 sc1
    buffer_load_dwordx4 v[130:133], v4, s[44:47], s89 offen offset:1024 sc1
    buffer_load_dwordx4 v[134:137], v4, s[44:47], s90 offen offset:1024 sc1
    buffer_load_dwordx4 v[138:141], v4, s[44:47], s91 offen offset:1024 sc1
    buffer_load_dwordx4 v[142:145], v4, s[44:47], s92 offen offset:1024 sc1
    buffer_load_dwordx4 v[146:149], v4, s[44:47], s93 offen offset:1024 sc1
    buffer_load_dwordx4 v[150:153], v4, s[44:47], s94 offen offset:1024 sc1
    s_mov_b32 exec_lo, 0xffff
    s_mov_b32 exec_hi, 0
    buffer_load_dword v159, v158, s[44:47], s12 offen sc1
    s_mov_b64 exec, -1
    s_waitcnt vmcnt(0)
    v_xor_b32 v161, s95, v159
    v_max3_u32 v160, v122, v123, v124
    v_max3_u32 v160, v160, v125, v126
    v_max3_u32 v160, v160, v127, v128
    v_max3_u32 v160, v160, v129, v130
    v_max3_u32 v160, v160, v131, v132
    v_max3_u32 v160, v160, v133, v134
    v_max3_u32 v160, v160, v135, v136
    v_max3_u32 v160, v160, v137, v138
    v_max3_u32 v160, v160, v139, v140
    v_max3_u32 v160, v160, v141, v142
    v_max3_u32 v160, v160, v143, v144
    v_max3_u32 v160, v160, v145, v146
    v_max3_u32 v160, v160, v147, v148
    v_max3_u32 v160, v160, v149, v150
    v_max3_u32 v160, v160, v151, v152
    v_max_u32 v160, v160, v153
    v_cmp_eq_u32 vcc, -1, v160
    v_cmp_ne_u32 s[10:11], 0, v161
    s_nop 0
    s_or_b64 vcc, vcc, s[10:11]
    s_nop 1
    s_cbranch_vccz L_pdq_30
    s_add_u32 s80, s80, 1
    s_cmp_lt_u32 s80, 200000
    s_cbranch_scc1 L_pollq_29
L_pdq_30:
    v_add_f32 v122, v122, v126
    v_add_f32 v123, v123, v127
    v_add_f32 v124, v124, v128
    v_add_f32 v125, v125, v129
    v_add_f32 v130, v130, v134
    v_add_f32 v131, v131, v135
    v_add_f32 v132, v132, v136
    v_add_f32 v133, v133, v137
    v_add_f32 v138, v138, v142
    v_add_f32 v139, v139, v143
    v_add_f32 v140, v140, v144
    v_add_f32 v141, v141, v145
    v_add_f32 v146, v146, v150
    v_add_f32 v147, v147, v151
    v_add_f32 v148, v148, v152
    v_add_f32 v149, v149, v153
    v_add_f32 v122, v122, v130
    v_add_f32 v123, v123, v131
    v_add_f32 v124, v124, v132
    v_add_f32 v125, v125, v133
    v_add_f32 v138, v138, v146
    v_add_f32 v139, v139, v147
    v_add_f32 v140, v140, v148
    v_add_f32 v141, v141, v149
    v_add_f32 v122, v122, v138
    v_add_f32 v123, v123, v139
    v_add_f32 v124, v124, v140
    v_add_f32 v125, v125, v141
    v_cvt_pk_bf16_f32 v126, v122, v123
    v_cvt_pk_bf16_f32 v127, v124, v125
    v_lshlrev_b32 v4, 3, v1
    ds_write_b64 v4, v[126:127] offset:0
    s_waitcnt lgkmcnt(0)
L_skipchain:
    s_barrier
    s_getpc_b64 s[8:9]
L_pc_31:
    s_bfe_u32 s7, s2, 0x30003
    s_mul_i32 s7, s7, 2048
    s_sub_u32 s8, s8, L_pc_31-adaLN_cond__gqa_block_cached__dense_activation_silu__decode_kernel
    s_subb_u32 s9, s9, 0
    v_lshlrev_b32 v8, 4, v1
    v_add_u32 v9, s7, v8
    s_add_u32 s7, s7, 0x400
    v_min_u32 v9, L_end-adaLN_cond__gqa_block_cached__dense_activation_silu__decode_kernel-16, v9
    global_load_dwordx4 v[12:15], v9, s[8:9]
    v_add_u32 v9, s7, v8
    s_add_u32 s7, s7, 0x400
    v_min_u32 v9, L_end-adaLN_cond__gqa_block_cached__dense_activation_silu__decode_kernel-16, v9
    global_load_dwordx4 v[16:19], v9, s[8:9]
    s_mov_b32 s72, 0xffff0000
    s_mov_b32 s73, 0
    s_mov_b32 s74, 0
    s_mov_b32 s75, 0xffff
    s_mov_b32 s76, 0
    s_mov_b32 s77, 0xffff0000
    s_barrier
    v_lshlrev_b32 v152, 4, v1
    v_mov_b32 v4, 0
    ds_read_b128 v[80:83], v4 offset:2560
    ds_read_b128 v[84:87], v4 offset:2576
    ds_read_b128 v[88:91], v4 offset:2592
    ds_read_b128 v[92:95], v4 offset:2608
    s_waitcnt lgkmcnt(0)
    v_max3_f32 v96, v80, v81, v82
    v_max3_f32 v96, v96, v83, v84
    v_max3_f32 v96, v96, v85, v86
    v_max_f32 v96, v96, v87
    v_max3_f32 v98, v88, v89, v90
    v_max3_f32 v98, v98, v91, v92
    v_max3_f32 v98, v98, v93, v94
    v_max_f32 v98, v98, v95
    s_barrier
    ds_read_b64 v[100:101], v4 offset:2624
    s_waitcnt lgkmcnt(0)
    v_mov_b32 v97, v100
    v_mov_b32 v99, v101
    s_mov_b32 exec_lo, 0xff
    s_mov_b32 exec_hi, 0x0
    buffer_store_dwordx4 v[96:99], v152, s[44:47], s85 offen offset:2560 sc1
    s_mov_b64 exec, -1
    s_barrier
    ds_read_b128 v[104:107], v152 offset:12032
    ds_read_b128 v[108:111], v152 offset:13056
    ds_read_b128 v[112:115], v152 offset:14080
    ds_read_b128 v[116:119], v152 offset:15104
    ds_read_b128 v[120:123], v152 offset:16128
    ds_read_b128 v[124:127], v152 offset:17152
    ds_read_b128 v[128:131], v152 offset:18176
    ds_read_b128 v[132:135], v152 offset:19200
    s_waitcnt lgkmcnt(6)
    v_add_f32 v104, v104, v108
    v_add_f32 v105, v105, v109
    v_add_f32 v106, v106, v110
    v_add_f32 v107, v107, v111
    s_waitcnt lgkmcnt(4)
    v_add_f32 v112, v112, v116
    v_add_f32 v113, v113, v117
    v_add_f32 v114, v114, v118
    v_add_f32 v115, v115, v119
    s_waitcnt lgkmcnt(2)
    v_add_f32 v120, v120, v124
    v_add_f32 v121, v121, v125
    v_add_f32 v122, v122, v126
    v_add_f32 v123, v123, v127
    s_waitcnt lgkmcnt(0)
    v_add_f32 v128, v128, v132
    v_add_f32 v129, v129, v133
    v_add_f32 v130, v130, v134
    v_add_f32 v131, v131, v135
    v_add_f32 v104, v104, v112
    v_add_f32 v105, v105, v113
    v_add_f32 v106, v106, v114
    v_add_f32 v107, v107, v115
    v_add_f32 v120, v120, v128
    v_add_f32 v121, v121, v129
    v_add_f32 v122, v122, v130
    v_add_f32 v123, v123, v131
    v_add_f32 v104, v104, v120
    v_add_f32 v105, v105, v121
    v_add_f32 v106, v106, v122
    v_add_f32 v107, v107, v123
    buffer_store_dwordx4 v[104:107], v152, s[44:47], s85 offen offset:1536 sc1
    s_cmp_eq_u32 s81, 2
    s_cbranch_scc1 L_mlp_tail
    s_cmp_eq_u32 s81, 1
    s_cbranch_scc1 L_cwo_32
    s_endpgm
L_cwo_32:
    s_lshl_b32 s7, s5, 4
    v_add_u32 v4, s7, v1
    v_mul_u32_u24 v4, s86, v4
    s_mov_b32 exec_lo, 0xffff
    s_mov_b32 exec_hi, 0x0
    s_mov_b32 s80, 0
L_pollml_33:
    buffer_load_dwordx4 v[80:83], v4, s[44:47], 0 offen offset:2560 sc1
    s_waitcnt vmcnt(0)
    v_max3_u32 v84, v80, v81, v82
    v_max_u32 v84, v84, v83
    v_cmp_eq_u32 vcc, -1, v84
    s_nop 0
    s_cbranch_vccz L_pdml_34
    s_add_u32 s80, s80, 1
    s_cmp_lt_u32 s80, 200000
    s_cbranch_scc1 L_pollml_33
L_pdml_34:
    s_cmp_eq_u32 s6, 0
    s_cbranch_scc0 L_nof4_35
    s_mov_b64 exec, -1
    v_mov_b32 v5, s95
    v_lshlrev_b32 v6, 2, v1
    s_lshl_b32 s7, s5, 7
    s_add_u32 s7, s7, 0x10d400
    s_mov_b32 exec_lo, 0xffffffff
    s_mov_b32 exec_hi, 0x0
    buffer_store_dword v5, v6, s[44:47], s7 offen sc1
    s_mov_b32 exec_lo, 0xffff
    s_mov_b32 exec_hi, 0x0
L_nof4_35:
    v_mov_b32 v84, v80
    v_mov_b32 v85, v82
    s_nop 0
    v_max_f32_dpp v84, v84, v84 row_ror:8 row_mask:0xf bank_mask:0xf
    v_max_f32_dpp v85, v85, v85 row_ror:8 row_mask:0xf bank_mask:0xf
    s_nop 0
    v_max_f32_dpp v84, v84, v84 row_ror:4 row_mask:0xf bank_mask:0xf
    v_max_f32_dpp v85, v85, v85 row_ror:4 row_mask:0xf bank_mask:0xf
    s_nop 0
    v_max_f32_dpp v84, v84, v84 row_ror:2 row_mask:0xf bank_mask:0xf
    v_max_f32_dpp v85, v85, v85 row_ror:2 row_mask:0xf bank_mask:0xf
    s_nop 0
    v_max_f32_dpp v84, v84, v84 row_ror:1 row_mask:0xf bank_mask:0xf
    v_max_f32_dpp v85, v85, v85 row_ror:1 row_mask:0xf bank_mask:0xf
    v_sub_f32 v80, v80, v84
    v_sub_f32 v82, v82, v85
    v_mul_f32 v80, 0x3fb8aa3b, v80
    v_mul_f32 v82, 0x3fb8aa3b, v82
    v_exp_f32 v80, v80
    v_exp_f32 v82, v82
    v_mul_f32 v84, v80, v81
    v_mul_f32 v85, v82, v83
    s_nop 0
    v_add_f32_dpp v84, v84, v84 row_ror:8 row_mask:0xf bank_mask:0xf
    v_add_f32_dpp v85, v85, v85 row_ror:8 row_mask:0xf bank_mask:0xf
    s_nop 0
    v_add_f32_dpp v84, v84, v84 row_ror:4 row_mask:0xf bank_mask:0xf
    v_add_f32_dpp v85, v85, v85 row_ror:4 row_mask:0xf bank_mask:0xf
    s_nop 0
    v_add_f32_dpp v84, v84, v84 row_ror:2 row_mask:0xf bank_mask:0xf
    v_add_f32_dpp v85, v85, v85 row_ror:2 row_mask:0xf bank_mask:0xf
    s_nop 0
    v_add_f32_dpp v84, v84, v84 row_ror:1 row_mask:0xf bank_mask:0xf
    v_add_f32_dpp v85, v85, v85 row_ror:1 row_mask:0xf bank_mask:0xf
    v_rcp_f32 v84, v84
    v_rcp_f32 v85, v85
    v_mul_f32 v80, v80, v84
    v_mul_f32 v82, v82, v85
    v_lshlrev_b32 v4, 2, v1
    ds_write_b32 v4, v80 offset:2688
    ds_write_b32 v4, v82 offset:2752
    s_waitcnt lgkmcnt(0)
    s_mov_b64 exec, -1
    s_barrier
    s_endpgm
L_end:
    s_endpgm
.section .rodata,"a"
.p2align 6
.amdhsa_kernel adaLN_cond__gqa_block_cached__dense_activation_silu__decode_kernel
  .amdhsa_next_free_vgpr 168
  .amdhsa_next_free_sgpr 100
  .amdhsa_accum_offset 168
  .amdhsa_group_segment_fixed_size 0
  .amdhsa_float_denorm_mode_32 3
  .amdhsa_kernarg_size 104
  .amdhsa_user_sgpr_count 2
  .amdhsa_user_sgpr_kernarg_segment_ptr 1
  .amdhsa_system_sgpr_workgroup_id_x 1
.end_amdhsa_kernel
```
